```python
import torch

def _softmax(x, axis=-1):
    return torch.softmax(x, dim=axis)
def _gelu(x):
    return torch.nn.functional.gelu(x, approximate="tanh")
def _silu(x):
    return torch.nn.functional.silu(x)
def _sigmoid(x):
    return torch.sigmoid(x)
def _layernorm(x, axis=-1, eps=1e-5):
    m = x.mean(dim=axis, keepdim=True)
    v = x.var(dim=axis, keepdim=True, unbiased=False)
    return (x - m) / torch.sqrt(v + eps)
def _scatter_add(tgt, idx, src, axis=0):
    return tgt.clone().index_add_(axis, idx, src)
def _segment_sum(src, seg, n):
    out = torch.zeros((n,) + src.shape[1:], dtype=src.dtype)
    return out.index_add_(0, seg, src)
def _pad(x, pw):
    flat = tuple(v for pair in reversed(pw) for v in pair)
    return torch.nn.functional.pad(x, flat)

kernel_name = 'concat_heads__ssm_conv_s4d__ssm_conv_s4__prompt'

def setup_inputs():

    _w = (lambda a: (lambda t: t.to(torch.bfloat16) if t.is_floating_point() else t)(torch.as_tensor(a)))
    def _A_setup():
        Bsz, L, D, N = 1, 2048, 512, 128
        return {
            "u": _w((lambda *s: torch.randn(*s, dtype=torch.bfloat16) * 0.05)(Bsz, L, D)),
            "log_A_real": _w((lambda *s: torch.randn(*s, dtype=torch.bfloat16) * 6.4)(D, N) * 0.5),
            "A_imag": _w((lambda *s: torch.randn(*s, dtype=torch.bfloat16) * 0.05)(D, N) * 3.14),
            "C_real": _w((lambda *s: torch.randn(*s, dtype=torch.bfloat16) * 0.05)(D, N) / N ** 0.5),
            "C_imag": _w((lambda *s: torch.randn(*s, dtype=torch.bfloat16) * 0.05)(D, N) / N ** 0.5),
            "log_dt": _w((lambda *s: torch.randn(*s, dtype=torch.bfloat16) * 0.05)(D) * 0.5 - 4.0),
            "D_skip": _w((lambda *s: torch.randn(*s, dtype=torch.bfloat16) * 0.05)(D)),
        }
    _A_in = _A_setup()

    def _B_setup():
        B, L, D, N = 1, 2048, 512, 128
        A_re = -(lambda _x: torch.exp(torch.as_tensor(_x)))((lambda *s: torch.randn(*s, dtype=torch.bfloat16) * 6.4)(D, N))
        A_im = torch.pi * (lambda *s: torch.randn(*s, dtype=torch.bfloat16) * 0.05)(D, N)
        B_re = (lambda *s: torch.randn(*s, dtype=torch.bfloat16) * 0.1)(D, N)
        B_im = (lambda *s: torch.randn(*s, dtype=torch.bfloat16) * 0.1)(D, N)
        C_re = (lambda *s: torch.randn(*s, dtype=torch.bfloat16) * 0.1)(D, N)
        C_im = (lambda *s: torch.randn(*s, dtype=torch.bfloat16) * 0.1)(D, N)
        log_dt = (lambda *s: torch.randn(*s, dtype=torch.bfloat16) * 0.05)(D) * 0.5 - 4.0
        Dskip = (lambda *s: torch.randn(*s, dtype=torch.bfloat16) * 0.05)(D)
        return {
            "u": _w((lambda *s: torch.randn(*s, dtype=torch.bfloat16) * 0.05)(B, L, D)),
            "A_re": _w(A_re),
            "A_im": _w(A_im),
            "B_re": _w(B_re),
            "B_im": _w(B_im),
            "C_re": _w(C_re),
            "C_im": _w(C_im),
            "log_dt": _w(log_dt),
            "Dskip": _w(Dskip),
        }
    _B_in = _B_setup()

    return {
        "A_u": _A_in["u"],
        "A_log_A_real": _A_in["log_A_real"],
        "A_A_imag": _A_in["A_imag"],
        "A_C_real": _A_in["C_real"],
        "A_C_imag": _A_in["C_imag"],
        "A_log_dt": _A_in["log_dt"],
        "A_D_skip": _A_in["D_skip"],
        "B_u": _B_in["u"],
        "B_A_re": _B_in["A_re"],
        "B_A_im": _B_in["A_im"],
        "B_B_re": _B_in["B_re"],
        "B_B_im": _B_in["B_im"],
        "B_C_re": _B_in["C_re"],
        "B_C_im": _B_in["C_im"],
        "B_log_dt": _B_in["log_dt"],
        "B_Dskip": _B_in["Dskip"],
    }

def reference(A_u, A_log_A_real, A_A_imag, A_C_real, A_C_imag, A_log_dt, A_D_skip, B_u, B_A_re, B_A_im, B_B_re, B_B_im, B_C_re, B_C_im, B_log_dt, B_Dskip):
    def _A_ref(u, log_A_real, A_imag, C_real, C_imag, log_dt, D_skip):
        L = u.shape[1]
        dt = torch.exp(log_dt)
        A = -torch.exp(log_A_real) + 1j * A_imag
        C = (C_real + 1j * C_imag) * dt[:, None]
        pos = (lambda x, dt: x.to(dt))(torch.arange(L), log_dt.dtype)
        P = torch.exp((A * dt[:, None])[:, :, None] * pos[None, None, :])
        K = 2.0 * torch.einsum("dn,dnl->dl", C, P).real
        L2 = 2 * L
        u_t = (lambda x, *d: x.permute(*d))(u, 0, 2, 1)
        Kf = (lambda x, *a, **k: torch.fft.rfft(x.float(), *a, **k))(K, L2)
        Uf = (lambda x, *a, **k: torch.fft.rfft(x.float(), *a, **k))(u_t, L2)
        y = (lambda x, *a, **k: torch.fft.irfft(x, *a, **k).to(torch.bfloat16))(Uf * Kf[None, :, :], L2)[:, :, :L]
        y = (lambda x, *d: x.permute(*d))(y, 0, 2, 1)
        return y + u * D_skip[None, None, :]

    def _B_ref(u, A_re, A_im, B_re, B_im, C_re, C_im, log_dt, Dskip):
        Bsz, L, D = u.shape
        dt = torch.exp(log_dt)[:, None]
        A = A_re + 1j * A_im
        Bc = B_re + 1j * B_im
        Cc = C_re + 1j * C_im
        logdA = dt * A
        dB = dt * Bc
        l = (lambda x, dt: x.to(dt))(torch.arange(L), A_re.dtype)
        P = torch.exp(logdA[:, :, None] * l[None, None, :])
        K = torch.einsum("dn,dnl,dn->dl", Cc, P, dB).real
        L2 = 2 * L
        Kp = _pad(K, ((0, 0), (0, L)))
        up = (lambda x, *d: x.permute(*d))(u, 0, 2, 1)
        up = _pad(up, ((0, 0), (0, 0), (0, L)))
        Kf = (lambda x, axes=(-2,-1): torch.fft.rfft2(x.float(), dim=axes))(Kp[:, None, :], axes=(-2, -1))
        Uf = (lambda x, axes=(-2,-1): torch.fft.rfft2(x.float(), dim=axes))(up[:, :, None, :], axes=(-2, -1))
        Yf = Uf * Kf[None, :, :, :]
        y = (lambda x, s, axes=(-2,-1): torch.fft.irfft2(x, s=s, dim=axes).to(torch.bfloat16))(Yf, (1, L2), axes=(-2, -1))[:, :, 0, :L]
        y = (lambda x, *d: x.permute(*d))(y, 0, 2, 1) + u * Dskip[None, None, :]
        return y

    a = _A_ref(A_u, A_log_A_real, A_A_imag, A_C_real, A_C_imag, A_log_dt, A_D_skip)
    b = _B_ref(B_u, B_A_re, B_A_im, B_B_re, B_B_im, B_C_re, B_C_im, B_log_dt, B_Dskip)
    return torch.concatenate([a, b], axis=-1)
```

```asm
; @launch grid=(256,1,1) block=(512,1,1) lds=129536
.amdgcn_target "amdgcn-amd-amdhsa--gfx950"
.text
.globl concat_heads__ssm_conv_s4d__ssm_conv_s4__prompt_kernel
.p2align 12
.fill 832, 4, 0xbf810000
.p2align 8
.type concat_heads__ssm_conv_s4d__ssm_conv_s4__prompt_kernel,@function
concat_heads__ssm_conv_s4d__ssm_conv_s4__prompt_kernel:
    s_bitcmp1_b32 s2, 7
    s_cselect_b32 s3, 56, 0
    s_load_dwordx16 s[4:19], s[0:1], s3
    s_load_dwordx4 s[20:23], s[0:1], 120
    s_cmpk_ge_u32 s2, 0x100
    s_cbranch_scc1 L_end
    s_getpc_b64 s[24:25]
    v_mul_u32_u24 v180, 3, v0
    v_mov_b32 v181, 0
    v_lshl_add_u64 v[180:181], v[180:181], 3, s[24:25]
    global_load_dword v173, v[180:181], off offset:64
L_nocp:
    v_readfirstlane_b32 s32, v0
    s_and_b32 s52, s2, 7
    s_lshl_b32 s52, s52, 7
    s_and_b32 s27, s2, 0x70
    s_or_b32 s33, s52, s27
    s_lshl_b32 s27, s33, 7
    v_lshl_add_u32 v199, v0, 2, s27
    s_lshr_b32 s32, s32, 6
    s_lshl1_add_u32 s41, s32, s33
    s_andn2_b32 s41, s41, 3
    v_and_b32 v198, 63, v0
    v_mov_b32 v114, 0x40004000
    v_mov_b32 v115, 0
    s_bfe_u32 s47, s2, 0x40003
    s_lshl_b32 s47, s47, 10
    s_add_u32 s47, s47, s52
    v_subrev_u32 v200, 448, v0
    v_lshlrev_b32 v200, 14, v200
    s_mov_b32 s58, 0x200000
    s_mov_b32 s59, 0x20000
    s_mul_i32 s35, s32, 11584
    v_and_b32 v201, 15, v0
    v_lshrrev_b32 v202, 4, v198
    s_add_u32 s35, s35, 36864
    s_mov_b32 m0, s35
    v_mov_b32 v186, 0x3f80
    v_mov_b32 v187, 1.0
    s_mov_b32 s24, 0x1c0000
    s_mov_b32 s25, 0xf8000
    s_mov_b32 s26, 0xfe00
    s_mov_b32 s27, 0x1ff0
    v_cndmask_b32_e64 v188, 0, v186, s[24:25]
    v_cndmask_b32_e64 v189, 0, v186, s[26:27]
    s_lshl_b64 s[24:25], s[24:25], 1
    s_lshl_b64 s[26:27], s[26:27], 1
    v_cndmask_b32_e64 v193, 0, v187, s[24:25]
    v_cndmask_b32_e64 v194, 0, v187, s[26:27]
    v_or_b32 v188, v188, v193
    v_or_b32 v189, v189, v194
    v_lshlrev_b32 v182, 2, v201
    v_mad_i32_i24 v190, v202, -16, v182
    v_mad_i32_i24 v193, v202, -16, s35
    v_add_u32 v192, v190, v193
    v_mov_b32 v60, 0
    v_mov_b32 v186, 0x3c00
    ds_write_addtid_b32 v188 offset:0
    ds_write_addtid_b32 v189 offset:256
    ds_write_addtid_b32 v60 offset:5760
    ds_write_addtid_b32 v186 offset:6912
    s_mul_i32 s50, s32, 4608
    ds_read2_b32 v[20:21], v192 offset0:31 offset1:25
    ds_read2_b32 v[22:23], v192 offset0:29 offset1:27
    ds_read2_b32 v[24:25], v192 offset0:57 offset1:51
    ds_read2_b32 v[26:27], v192 offset0:55 offset1:53
    ds_read2_b32 v[28:29], v192 offset0:84 offset1:78
    ds_read2_b32 v[30:31], v192 offset0:82 offset1:80
    ds_read2_b32 v[32:33], v192 offset0:112 offset1:106
    ds_read2_b32 v[34:35], v192 offset0:110 offset1:108
    s_mov_b32 m0, s50
    s_movk_i32 s48, 288
    ds_write_addtid_b32 v60 offset:0
    ds_write_addtid_b32 v60 offset:256
    s_mov_b32 m0, s35
    s_mov_b32 s24, 0x7c8a1604
    s_mov_b32 s25, 0xf2ddd3ee
    s_mov_b32 s26, 0xbfa8e132
    s_mov_b32 s27, 0xd7779cc5
    s_bitcmp0_b32 s2, 3
    s_cmov_b32 s26, 0xcfa8e132
    s_cmov_b32 s27, 0xc777ccc5
    v_lshl_add_u32 v168, v202, 4, s35
    v_mad_u32_u24 v169, v201, s48, v168
    v_lshrrev_b64 v[184:185], v182, s[24:25]
    v_and_b32 v184, 15, v184
    v_mad_u32_u24 v170, v184, s48, v168
    s_cmp_lg_u32 s3, 0
    s_waitcnt lgkmcnt(0)
    s_cselect_b64 s[28:29], s[18:19], s[14:15]
    s_load_dword s36, s[28:29], s41
    global_load_dword v196, v199, s[6:7]
    global_load_dword v197, v199, s[8:9]
    s_cselect_b64 s[30:31], s[20:21], s[16:17]
    s_load_dword s37, s[30:31], s41
    global_load_dword v112, v199, s[10:11]
    global_load_dword v113, v199, s[12:13]
    s_cbranch_scc0 L_noB
    global_load_dword v114, v199, s[14:15]
    global_load_dword v115, v199, s[16:17]
L_noB:
    s_mov_b32 s56, s4
    s_mov_b32 s57, s5
    v_lshrrev_b64 v[184:185], v182, s[26:27]
    v_and_b32 v184, 15, v184
    v_mad_u32_u24 v171, v184, s48, v168
    s_add_u32 s48, s35, 3444
    v_add_u32 v38, s48, v190
    v_lshl_add_u32 v37, v190, 1, s35
    v_lshl_add_u32 v191, v201, 1, v202
    v_lshl_add_u32 v1, v191, 4, s50
    v_lshl_add_u32 v167, v191, 3, -8
    v_lshrrev_b32 v194, 1, v202
    v_mad_u32_u24 v191, v194, 62, v191
    v_min_u32 v194, 1, v202
    v_mul_u32_u24 v194, 192, v194
    v_sub_u32 v194, v194, v198
    v_add_u32 v2, 292, v192
    v_add_u32 v36, 1316, v192
    v_add_u32 v3, 2340, v192
    v_lshl_add_u32 v43, v191, 4, s35
    v_lshl_add_u32 v163, v194, 4, s35
    s_add_u32 s49, s35, 3072
    v_lshl_add_u32 v193, v202, 5, v201
    v_lshl_add_u32 v165, v193, 2, s49
    v_lshl_add_u32 v166, v193, 1, s35
    v_mov_b32 v61, 0
    v_mov_b32 v62, 0
    v_mov_b32 v63, 0
    v_mov_b32 v161, 0
    v_mad_u32_u24 v39, v202, 18, v201
    v_lshl_add_u32 v39, v39, 3, s35
    v_lshrrev_b32 v193, 2, v201
    buffer_load_dword v173, v200, s[56:59], s47 offen
    s_mov_b64 s[60:61], s[22:23]
    v_mul_u32_u24 v193, 1376, v193
    v_bfe_u32 v194, v0, 4, 4
    v_mad_u32_u24 v194, v201, 18, v194
    s_mov_b32 s49, 43840
    v_add_u32_e64 v193, v193, v194
    v_lshl_add_u32 v40, v193, 3, s49
    v_and_b32 v41, 0xff, v0
    v_lshlrev_b32_e64 v41, 11, v41
    s_add_u32 s53, s33, 0x100000
    s_mov_b32 s38, 0x05040100
    s_mov_b32 s39, 0x07060302
    s_mov_b32 s51, 0xffff0000
    s_lshl_b32 s54, s32, 8
    s_addk_i32 s54, 512
    s_add_u32 s55, s54, 2048
    s_lshr_b32 s48, s2, 7
    s_xor_b32 s44, s48, 1
    s_lshl_b32 s48, s48, 10
    s_add_u32 s34, s33, s48
    s_lshl_b32 s44, s44, 31
    s_or_b32 s44, s44, 0x3fb8aa3b
    s_mov_b32 s40, 0x3fb8aa00
    s_movk_i32 s45, 258
    s_mov_b32 s42, 0x36a407db
    s_lshl_b32 s49, s32, 3
    s_and_b32 s49, s49, 32
    s_bfm_b64 s[26:27], 32, s49
    s_mov_b32 s63, 0x20000
    v_xor_b32 v205, 0, v0
    v_lshlrev_b32 v205, 14, v205
    s_add_u32 s25, s47, 1048576
    s_mov_b64 s[16:17], s[56:57]
    s_mov_b64 s[18:19], s[58:59]
    s_movk_i32 s47, 156
    v_and_b32 v180, 3, v0
    v_lshlrev_b32 v180, 1, v180
    v_lshrrev_b32_e64 v180, v180, s47
    v_bfi_b32 v172, 3, v180, v0
    v_lshlrev_b32 v172, 11, v172
    s_bitcmp1_b32 s2, 3
    s_cselect_b32 s58, s58, 1310720
    s_lshl_b32 s52, s32, 4
    v_mov_b32 v193, s40
    v_mov_b32 v194, s42
    s_waitcnt lgkmcnt(0)
    s_lshr_b32 s36, s36, s52
    s_lshr_b32 s37, s37, s52
    s_lshl_b32 s36, s36, 16
    s_lshl_b32 s37, s37, 16
    v_mul_f32 v193, s36, v193
    v_mul_f32 v194, s36, v194
    v_exp_f32 v193, v193
    v_writelane_b32 v161, s37, 0
    v_fma_f32 v193, v193, v194, v193
    v_cvt_pk_bf16_f32 v193, v193, v193
    v_and_b32 v193, s51, v193
    v_mul_f32 v194, s44, v193
    v_mul_f32 v192, 0.15915494, v193
    s_bitcmp1_b32 s2, 7
    s_setprio 3
    s_waitcnt vmcnt(5)
    s_cbranch_scc1 L_prepC
    s_waitcnt vmcnt(4)
    v_lshlrev_b32 v184, 16, v196
    v_and_b32_e64 v185, s51, v196
    v_pk_mul_f32 v[186:187], v[184:185], s[40:41] op_sel_hi:[1,0]
    v_exp_f32 v186, v186
    v_exp_f32 v187, v187
    v_pk_mul_f32 v[184:185], v[184:185], s[42:43] op_sel_hi:[1,0]
    v_pk_fma_f32 v[186:187], v[186:187], v[184:185], v[186:187]
    v_cvt_pk_bf16_f32 v196, v186, v187
    s_waitcnt vmcnt(3)
.p2align 3
L_prepC:
    v_lshlrev_b32 v186, 16, v197
    v_and_b32 v187, s51, v197
    v_lshlrev_b32 v184, 16, v196
    v_and_b32 v185, s51, v196
    v_pk_mul_f32 v[176:177], v[186:187], v[192:193] op_sel_hi:[1,0]
    v_pk_mul_f32 v[174:175], v[184:185], v[194:195] op_sel_hi:[1,0]
    v_cos_f32 v188, v176
    v_sin_f32 v189, v176
    v_exp_f32_e64 v190, v174
    s_mov_b32 s43, 0x44800000
    v_pk_mul_f32 v[188:189], v[188:189], v[190:191] op_sel_hi:[1,0]
    v_cvt_pk_f16_f32 v196, v188, v189
    v_pk_mul_f32 v[190:191], v[188:189], v[188:189] op_sel:[1,1] op_sel_hi:[1,0] neg_lo:[1,0]
    v_pk_fma_f32 v[188:189], v[188:189], v[188:189], v[190:191] op_sel:[0,0,0] op_sel_hi:[0,1,1]
    v_pk_mul_f32 v[190:191], v[188:189], v[188:189] op_sel:[1,1] op_sel_hi:[1,0] neg_lo:[1,0]
    v_pk_fma_f32 v[188:189], v[188:189], v[188:189], v[190:191] op_sel:[0,0,0] op_sel_hi:[0,1,1]
    v_cvt_pk_f16_f32 v197, v188, v189
    v_pk_mul_f32 v[190:191], v[188:189], v[188:189] op_sel:[1,1] op_sel_hi:[1,0] neg_lo:[1,0]
    v_pk_fma_f32 v[188:189], v[188:189], v[188:189], v[190:191] op_sel:[0,0,0] op_sel_hi:[0,1,1]
    v_cvt_pk_f16_f32 v198, v188, v189
    v_pk_mul_f32 v[190:191], v[188:189], v[188:189] op_sel:[1,1] op_sel_hi:[1,0] neg_lo:[1,0]
    v_pk_fma_f32 v[188:189], v[188:189], v[188:189], v[190:191] op_sel:[0,0,0] op_sel_hi:[0,1,1]
    v_cvt_pk_f16_f32 v199, v188, v189
    v_pk_mul_f16 v184, v198, v199 op_sel:[1,1] op_sel_hi:[1,0] neg_lo:[1,0]
    v_pk_fma_f16 v227, v198, v199, v184 op_sel:[0,0,0] op_sel_hi:[0,1,1]
    v_pk_mul_f32 v[190:191], v[188:189], v[188:189] op_sel:[1,1] op_sel_hi:[1,0] neg_lo:[1,0]
    v_pk_fma_f32 v[188:189], v[188:189], v[188:189], v[190:191] op_sel:[0,0,0] op_sel_hi:[0,1,1]
    ds_write_addtid_b32 v198 offset:7200
    ds_write_addtid_b32 v199 offset:7488
    ds_write_addtid_b32 v227 offset:7776
    v_cvt_pk_f16_f32 v200, v188, v189
    v_pk_mul_f16 v185, v198, v200 op_sel:[1,1] op_sel_hi:[1,0] neg_lo:[1,0]
    v_pk_fma_f16 v228, v198, v200, v185 op_sel:[0,0,0] op_sel_hi:[0,1,1]
    v_pk_mul_f32 v[190:191], v[188:189], v[188:189] op_sel:[1,1] op_sel_hi:[1,0] neg_lo:[1,0]
    v_pk_fma_f32 v[188:189], v[188:189], v[188:189], v[190:191] op_sel:[0,0,0] op_sel_hi:[0,1,1]
    v_cvt_pk_f16_f32 v201, v188, v189
    v_pk_mul_f16 v186, v199, v200 op_sel:[1,1] op_sel_hi:[1,0] neg_lo:[1,0]
    v_pk_fma_f16 v229, v199, v200, v186 op_sel:[0,0,0] op_sel_hi:[0,1,1]
    v_pk_mul_f16 v187, v227, v200 op_sel:[1,1] op_sel_hi:[1,0] neg_lo:[1,0]
    v_pk_fma_f16 v230, v227, v200, v187 op_sel:[0,0,0] op_sel_hi:[0,1,1]
    ds_write_addtid_b32 v200 offset:8064
    ds_write_addtid_b32 v228 offset:8352
    ds_write_addtid_b32 v201 offset:9216
    ds_write_addtid_b32 v229 offset:8640
    v_pk_mul_f32 v[190:191], v[188:189], v[188:189] op_sel:[1,1] op_sel_hi:[1,0] neg_lo:[1,0]
    v_pk_fma_f32 v[188:189], v[188:189], v[188:189], v[190:191] op_sel:[0,0,0] op_sel_hi:[0,1,1]
    v_cvt_pk_f16_f32 v202, v188, v189
    v_pk_mul_f16 v184, v198, v201 op_sel:[1,1] op_sel_hi:[1,0] neg_lo:[1,0]
    v_pk_fma_f16 v218, v198, v201, v184 op_sel:[0,0,0] op_sel_hi:[0,1,1]
    s_waitcnt vmcnt(1)
    s_nop 0
    buffer_load_dwordx4 v[4:7], v172, s[56:59], s33 offen
    buffer_load_dwordx4 v[8:11], v172, s[56:59], s33 offen offset:1024
    v_lshlrev_b32 v146, 16, v113
    v_and_b32 v147, s51, v113
    v_lshlrev_b32 v150, 16, v115
    v_and_b32 v151, s51, v115
    v_lshlrev_b32_e64 v148, 16, v114
    ds_write_addtid_b32 v230 offset:8928
    ds_write_addtid_b32 v202 offset:1440
    ds_read_b128 v[128:131], v168 offset:1440
    ds_write_addtid_b32 v218 offset:9504
    v_and_b32 v149, s51, v114
    v_lshlrev_b32 v144, 16, v112
    v_and_b32_e64 v145, s51, v112
    v_pk_mul_f32 v[180:181], v[146:147], v[150:151] neg_lo:[1,0] neg_hi:[1,0]
    v_pk_mul_f32 v[182:183], v[146:147], v[148:149]
    v_pk_fma_f32 v[180:181], v[144:145], v[148:149], v[180:181]
    v_pk_fma_f32 v[182:183], v[144:145], v[150:151], v[182:183]
    v_max3_f32 v195, |v180|, |v181|, |v182|
    v_max_f32_e64 v195, v195, |v183|
    v_pk_mul_f16 v185, v199, v201 op_sel:[1,1] op_sel_hi:[1,0] neg_lo:[1,0]
    ds_read_b128 v[132:135], v168 offset:1504
    ds_read_b128 v[136:139], v168 offset:1568
    v_pk_fma_f16 v226, v199, v201, v185 op_sel:[0,0,0] op_sel_hi:[0,1,1]
    v_max_u32_dpp v195, v195, v195 row_shr:1 row_mask:0xf bank_mask:0xf
    v_pk_mul_f16 v186, v227, v201 op_sel:[1,1] op_sel_hi:[1,0] neg_lo:[1,0]
    v_pk_fma_f16 v224, v227, v201, v186 op_sel:[0,0,0] op_sel_hi:[0,1,1]
    v_max_u32_dpp v195, v195, v195 row_shr:2 row_mask:0xf bank_mask:0xf
    v_pk_mul_f16 v187, v200, v201 op_sel:[1,1] op_sel_hi:[1,0] neg_lo:[1,0]
    v_pk_fma_f16 v225, v200, v201, v187 op_sel:[0,0,0] op_sel_hi:[0,1,1]
    ds_read_b128 v[140:143], v168 offset:1632
    ds_write_addtid_b32 v226 offset:9792
    ds_write_addtid_b32 v224 offset:10080
    v_max_u32_dpp v195, v195, v195 row_shr:4 row_mask:0xf bank_mask:0xf
    v_pk_mul_f16 v184, v228, v201 op_sel:[1,1] op_sel_hi:[1,0] neg_lo:[1,0]
    v_pk_fma_f16 v223, v228, v201, v184 op_sel:[0,0,0] op_sel_hi:[0,1,1]
    v_max_u32_dpp v195, v195, v195 row_shr:8 row_mask:0xf bank_mask:0xf
    v_pk_mul_f16 v185, v229, v201 op_sel:[1,1] op_sel_hi:[1,0] neg_lo:[1,0]
    v_pk_fma_f16 v220, v229, v201, v185 op_sel:[0,0,0] op_sel_hi:[0,1,1]
    v_max_u32_dpp v195, v195, v195 row_bcast:15 row_mask:0xa bank_mask:0xf
    ds_write_addtid_b32 v225 offset:10368
    ds_write_addtid_b32 v223 offset:10656
    ds_write_addtid_b32 v220 offset:10944
    v_pk_mul_f16 v186, v230, v201 op_sel:[1,1] op_sel_hi:[1,0] neg_lo:[1,0]
    v_pk_fma_f16 v222, v230, v201, v186 op_sel:[0,0,0] op_sel_hi:[0,1,1]
    v_max_u32_dpp v195, v195, v195 row_bcast:31 row_mask:0xc bank_mask:0xf
    v_pk_mul_f32 v[190:191], v[188:189], v[188:189] op_sel:[1,1] op_sel_hi:[1,0] neg_lo:[1,0]
    v_readlane_b32 s48, v195, 63
    v_pk_fma_f32 v[188:189], v[188:189], v[188:189], v[190:191] op_sel:[0,0,0] op_sel_hi:[0,1,1]
    v_cvt_pk_f16_f32 v203, v188, v189
    v_pk_mul_f32 v[190:191], v[188:189], v[188:189] op_sel:[1,1] op_sel_hi:[1,0] neg_lo:[1,0]
    s_lshr_b32 s48, s48, 23
    s_max_u32 s48, s48, 5
    ds_write_addtid_b32 v222 offset:11232
    ds_read_b128 v[96:99], v169 offset:6912
    v_pk_fma_f32 v[188:189], v[188:189], v[188:189], v[190:191] op_sel:[0,0,0] op_sel_hi:[0,1,1]
    v_cvt_pk_f16_f32 v204, v188, v189
    s_sub_u32 s45, s45, s48
    s_lshl_b32 s45, s45, 23
    v_fma_mixlo_f16 v178, v180, s45, 0
    v_fma_mixlo_f16 v179, v181, s45, 0
    v_fma_mixhi_f16 v178, -v182, s45, 0
    v_fma_mixhi_f16 v179, -v183, s45, 0
    v_fma_f32 v194, v174, s43, |v176|
    v_fma_f32 v192, v175, s43, |v177|
    s_sub_u32 s46, s48, 4
    s_lshl_b32 s46, s46, 23
    ds_read_b128 v[100:103], v169 offset:6976
    ds_read_b128 v[104:107], v169 offset:7040
    v_max_f32 v194, v194, v192
    v_cmp_nge_f32 vcc, 2.0, v194
    v_pk_mul_f16 v187, v178, v196 op_sel:[1,1] op_sel_hi:[1,0]
    v_pk_fma_f16 v206, v178, v196, v187 op_sel:[0,0,0] op_sel_hi:[0,1,1] neg_hi:[1,0,0]
    v_pk_mul_f16 v184, v206, v196 op_sel:[1,1] op_sel_hi:[1,0]
    v_pk_fma_f16 v207, v206, v196, v184 op_sel:[0,0,0] op_sel_hi:[0,1,1] neg_hi:[1,0,0]
    v_pk_mul_f16 v185, v178, v197 op_sel:[1,1] op_sel_hi:[1,0]
    v_pk_fma_f16 v209, v178, v197, v185 op_sel:[0,0,0] op_sel_hi:[0,1,1] neg_hi:[1,0,0]
    ds_read_b128 v[108:111], v169 offset:7104
    ds_write_addtid_b32 v178 offset:1152
    ds_write_addtid_b32 v206 offset:0
    v_pk_mul_f16 v186, v207, v196 op_sel:[1,1] op_sel_hi:[1,0]
    v_pk_fma_f16 v208, v207, v196, v186 op_sel:[0,0,0] op_sel_hi:[0,1,1] neg_hi:[1,0,0]
    v_pk_mul_f16 v187, v206, v197 op_sel:[1,1] op_sel_hi:[1,0]
    v_pk_fma_f16 v210, v206, v197, v187 op_sel:[0,0,0] op_sel_hi:[0,1,1] neg_hi:[1,0,0]
    v_pk_mul_f16 v184, v207, v197 op_sel:[1,1] op_sel_hi:[1,0]
    v_pk_fma_f16 v211, v207, v197, v184 op_sel:[0,0,0] op_sel_hi:[0,1,1] neg_hi:[1,0,0]
    v_pk_mul_f16 v185, v208, v197 op_sel:[1,1] op_sel_hi:[1,0]
    v_pk_fma_f16 v212, v208, v197, v185 op_sel:[0,0,0] op_sel_hi:[0,1,1] neg_hi:[1,0,0]
    ds_write_addtid_b32 v207 offset:1728
    ds_write_addtid_b32 v209 offset:2880
    ds_write_addtid_b32 v208 offset:288
    ds_write_addtid_b32 v210 offset:2304
    v_pk_mul_f16 v186, v178, v198 op_sel:[1,1] op_sel_hi:[1,0]
    v_pk_fma_f16 v221, v178, v198, v186 op_sel:[0,0,0] op_sel_hi:[0,1,1] neg_hi:[1,0,0]
    v_pk_mul_f16 v187, v178, v203 op_sel:[1,1] op_sel_hi:[1,0]
    v_pk_fma_f16 v213, v178, v203, v187 op_sel:[0,0,0] op_sel_hi:[0,1,1] neg_hi:[1,0,0]
    v_pk_mul_f16 v184, v207, v203 op_sel:[1,1] op_sel_hi:[1,0]
    v_pk_fma_f16 v214, v207, v203, v184 op_sel:[0,0,0] op_sel_hi:[0,1,1] neg_hi:[1,0,0]
    v_pk_mul_f16 v185, v209, v203 op_sel:[1,1] op_sel_hi:[1,0]
    v_pk_fma_f16 v215, v209, v203, v185 op_sel:[0,0,0] op_sel_hi:[0,1,1] neg_hi:[1,0,0]
    ds_write_addtid_b32 v211 offset:3456
    ds_write_addtid_b32 v212 offset:2016
    ds_write_addtid_b32 v221 offset:4608
    ds_write_addtid_b32 v213 offset:4032
    v_pk_mul_f16 v186, v211, v203 op_sel:[1,1] op_sel_hi:[1,0]
    v_pk_fma_f16 v216, v211, v203, v186 op_sel:[0,0,0] op_sel_hi:[0,1,1] neg_hi:[1,0,0]
    v_pk_mul_f16 v187, v221, v203 op_sel:[1,1] op_sel_hi:[1,0]
    v_pk_fma_f16 v217, v221, v203, v187 op_sel:[0,0,0] op_sel_hi:[0,1,1] neg_hi:[1,0,0]
    v_pk_mul_f16 v184, v209, v204 op_sel:[1,1] op_sel_hi:[1,0]
    v_pk_fma_f16 v218, v209, v204, v184 op_sel:[0,0,0] op_sel_hi:[0,1,1] neg_hi:[1,0,0]
    v_pk_mul_f16 v185, v221, v204 op_sel:[1,1] op_sel_hi:[1,0]
    ds_write_addtid_b32 v214 offset:864
    ds_write_addtid_b32 v215 offset:3744
    ds_write_addtid_b32 v216 offset:576
    v_pk_fma_f16 v219, v221, v204, v185 op_sel:[0,0,0] op_sel_hi:[0,1,1] neg_hi:[1,0,0]
    v_pk_mul_f16 v186, v215, v204 op_sel:[1,1] op_sel_hi:[1,0]
    v_pk_fma_f16 v226, v215, v204, v186 op_sel:[0,0,0] op_sel_hi:[0,1,1] neg_hi:[1,0,0]
    v_pk_mul_f16 v187, v217, v204 op_sel:[1,1] op_sel_hi:[1,0]
    v_pk_fma_f16 v222, v217, v204, v187 op_sel:[0,0,0] op_sel_hi:[0,1,1] neg_hi:[1,0,0]
    v_pk_mul_f16 v184, v219, v204 op_sel:[1,1] op_sel_hi:[1,0]
    ds_write_addtid_b32 v217 offset:4320
    ds_read_b128 v[64:67], v170 offset:0
    v_pk_fma_f16 v220, v219, v204, v184 op_sel:[0,0,0] op_sel_hi:[0,1,1] neg_hi:[1,0,0]
    s_bitcmp1_b32 s2, 3
    s_cbranch_scc0 L_sk0
    v_pk_mul_f16 v185, v222, v204 op_sel:[1,1] op_sel_hi:[1,0]
    v_pk_fma_f16 v223, v222, v204, v185 op_sel:[0,0,0] op_sel_hi:[0,1,1] neg_hi:[1,0,0]
    v_pk_mul_f16 v186, v220, v204 op_sel:[1,1] op_sel_hi:[1,0]
    v_pk_fma_f16 v224, v220, v204, v186 op_sel:[0,0,0] op_sel_hi:[0,1,1] neg_hi:[1,0,0]
    v_pk_mul_f16 v187, v223, v204 op_sel:[1,1] op_sel_hi:[1,0]
    v_pk_fma_f16 v225, v223, v204, v187 op_sel:[0,0,0] op_sel_hi:[0,1,1] neg_hi:[1,0,0]
    ds_write_addtid_b32 v223 offset:5472
    ds_write_addtid_b32 v224 offset:4896
    ds_write_addtid_b32 v225 offset:6048
L_sk0:
    s_setprio 2
    v_cos_f32 v188, v177
    v_sin_f32_e64 v189, v177
    v_exp_f32_e64 v190, v175
    ds_write_addtid_b32 v218 offset:3168
    ds_write_addtid_b32 v219 offset:2592
    ds_write_addtid_b32 v226 offset:5184
    v_mul_f32_e64 v160, s46, v193
    v_pk_mul_f32 v[188:189], v[188:189], v[190:191] op_sel_hi:[1,0]
    v_cvt_pk_f16_f32 v196, v188, v189
    v_pk_mul_f32 v[190:191], v[188:189], v[188:189] op_sel:[1,1] op_sel_hi:[1,0] neg_lo:[1,0]
    ds_write_addtid_b32 v222 offset:6624
    ds_write_addtid_b32 v220 offset:6336
    ds_read_b128 v[68:71], v170 offset:64
    v_pk_fma_f32 v[188:189], v[188:189], v[188:189], v[190:191] op_sel:[0,0,0] op_sel_hi:[0,1,1]
    v_pk_mul_f32 v[190:191], v[188:189], v[188:189] op_sel:[1,1] op_sel_hi:[1,0] neg_lo:[1,0]
    v_pk_fma_f32 v[188:189], v[188:189], v[188:189], v[190:191] op_sel:[0,0,0] op_sel_hi:[0,1,1]
    v_cvt_pk_f16_f32 v197, v188, v189
    v_pk_mul_f32 v[190:191], v[188:189], v[188:189] op_sel:[1,1] op_sel_hi:[1,0] neg_lo:[1,0]
    v_pk_fma_f32 v[188:189], v[188:189], v[188:189], v[190:191] op_sel:[0,0,0] op_sel_hi:[0,1,1]
    v_cvt_pk_f16_f32 v198, v188, v189
    v_pk_mul_f32 v[190:191], v[188:189], v[188:189] op_sel:[1,1] op_sel_hi:[1,0] neg_lo:[1,0]
    v_pk_fma_f32 v[188:189], v[188:189], v[188:189], v[190:191] op_sel:[0,0,0] op_sel_hi:[0,1,1]
    v_cvt_pk_f16_f32 v199, v188, v189
    ds_read_b128 v[72:75], v170 offset:128
    v_pk_mul_f32 v[190:191], v[188:189], v[188:189] op_sel:[1,1] op_sel_hi:[1,0] neg_lo:[1,0]
    v_pk_fma_f32 v[188:189], v[188:189], v[188:189], v[190:191] op_sel:[0,0,0] op_sel_hi:[0,1,1]
    v_cvt_pk_f16_f32 v200, v188, v189
    v_pk_mul_f32 v[190:191], v[188:189], v[188:189] op_sel:[1,1] op_sel_hi:[1,0] neg_lo:[1,0]
    v_pk_fma_f32 v[188:189], v[188:189], v[188:189], v[190:191] op_sel:[0,0,0] op_sel_hi:[0,1,1]
    ds_read_b128 v[76:79], v170 offset:192
    v_cvt_pk_f16_f32 v201, v188, v189
    v_pk_mul_f32 v[190:191], v[188:189], v[188:189] op_sel:[1,1] op_sel_hi:[1,0] neg_lo:[1,0]
    v_pk_fma_f32 v[188:189], v[188:189], v[188:189], v[190:191] op_sel:[0,0,0] op_sel_hi:[0,1,1]
    v_cvt_pk_f16_f32 v202, v188, v189
    v_pk_mul_f32 v[190:191], v[188:189], v[188:189] op_sel:[1,1] op_sel_hi:[1,0] neg_lo:[1,0]
    v_pk_fma_f32 v[188:189], v[188:189], v[188:189], v[190:191] op_sel:[0,0,0] op_sel_hi:[0,1,1]
    v_cvt_pk_f16_f32 v203, v188, v189
    v_pk_mul_f32 v[190:191], v[188:189], v[188:189] op_sel:[1,1] op_sel_hi:[1,0] neg_lo:[1,0]
    v_pk_fma_f32 v[188:189], v[188:189], v[188:189], v[190:191] op_sel:[0,0,0] op_sel_hi:[0,1,1]
    v_cvt_pk_f16_f32 v204, v188, v189
    s_waitcnt lgkmcnt(0)
    s_nop 0
    ds_read_b128 v[80:83], v171 offset:2304
    ds_read_b128 v[84:87], v171 offset:2368
    v_mfma_f32_16x16x32_f16 v[44:47], v[64:67], v[96:99], 0
    v_pk_mul_f16 v184, v96, v128 op_sel:[1,1] op_sel_hi:[1,0] neg_lo:[1,0]
    v_pk_fma_f16 v128, v96, v128, v184 op_sel:[0,0,0] op_sel_hi:[0,1,1]
    v_pk_mul_f16 v184, v198, v199 op_sel:[1,1] op_sel_hi:[1,0] neg_lo:[1,0]
    v_pk_fma_f16 v227, v198, v199, v184 op_sel:[0,0,0] op_sel_hi:[0,1,1]
    v_pk_mul_f16 v185, v198, v200 op_sel:[1,1] op_sel_hi:[1,0] neg_lo:[1,0]
    v_pk_fma_f16 v228, v198, v200, v185 op_sel:[0,0,0] op_sel_hi:[0,1,1]
    ds_read_b128 v[88:91], v171 offset:2432
    ds_write_addtid_b32 v202 offset:1440
    ds_write_addtid_b32 v198 offset:7200
    v_mfma_f32_16x16x32_f16 v[44:47], v[68:71], v[100:103], v[44:47]
    v_pk_mul_f16 v185, v97, v129 op_sel:[1,1] op_sel_hi:[1,0] neg_lo:[1,0]
    v_pk_fma_f16 v129, v97, v129, v185 op_sel:[0,0,0] op_sel_hi:[0,1,1]
    v_pk_mul_f16 v186, v199, v200 op_sel:[1,1] op_sel_hi:[1,0] neg_lo:[1,0]
    v_pk_fma_f16 v229, v199, v200, v186 op_sel:[0,0,0] op_sel_hi:[0,1,1]
    v_pk_mul_f16 v187, v227, v200 op_sel:[1,1] op_sel_hi:[1,0] neg_lo:[1,0]
    v_pk_fma_f16 v230, v227, v200, v187 op_sel:[0,0,0] op_sel_hi:[0,1,1]
    ds_read_b128 v[92:95], v171 offset:2496
    ds_write_addtid_b32 v199 offset:7488
    ds_write_addtid_b32 v200 offset:8064
    buffer_load_dword v42, v205, s[16:19], s25 offen
    v_mfma_f32_16x16x32_f16 v[44:47], v[72:75], v[104:107], v[44:47]
    v_pk_mul_f16 v186, v98, v130 op_sel:[1,1] op_sel_hi:[1,0] neg_lo:[1,0]
    v_pk_fma_f16 v130, v98, v130, v186 op_sel:[0,0,0] op_sel_hi:[0,1,1]
    v_pk_mul_f16 v184, v198, v201 op_sel:[1,1] op_sel_hi:[1,0] neg_lo:[1,0]
    v_pk_fma_f16 v218, v198, v201, v184 op_sel:[0,0,0] op_sel_hi:[0,1,1]
    v_pk_mul_f16 v185, v199, v201 op_sel:[1,1] op_sel_hi:[1,0] neg_lo:[1,0]
    v_pk_fma_f16 v226, v199, v201, v185 op_sel:[0,0,0] op_sel_hi:[0,1,1]
    ds_read_b128 v[144:147], v168 offset:1440
    ds_write_addtid_b32 v201 offset:9216
    ds_write_addtid_b32 v227 offset:7776
    v_mfma_f32_16x16x32_f16 v[44:47], v[76:79], v[108:111], v[44:47]
    v_pk_mul_f16 v187, v99, v131 op_sel:[1,1] op_sel_hi:[1,0] neg_lo:[1,0]
    v_pk_fma_f16 v131, v99, v131, v187 op_sel:[0,0,0] op_sel_hi:[0,1,1]
    v_pk_mul_f16 v186, v227, v201 op_sel:[1,1] op_sel_hi:[1,0] neg_lo:[1,0]
    v_pk_fma_f16 v224, v227, v201, v186 op_sel:[0,0,0] op_sel_hi:[0,1,1]
    v_pk_mul_f16 v187, v200, v201 op_sel:[1,1] op_sel_hi:[1,0] neg_lo:[1,0]
    v_pk_fma_f16 v225, v200, v201, v187 op_sel:[0,0,0] op_sel_hi:[0,1,1]
    s_waitcnt lgkmcnt(10)
    s_nop 0
    ds_write_addtid_b32 v228 offset:8352
    ds_write_addtid_b32 v229 offset:8640
    ds_write_addtid_b32 v230 offset:8928
    v_mfma_f32_16x16x32_f16 v[52:55], v[80:83], v[96:99], 0
    v_pk_mul_f16 v184, v100, v132 op_sel:[1,1] op_sel_hi:[1,0] neg_lo:[1,0]
    v_pk_fma_f16 v132, v100, v132, v184 op_sel:[0,0,0] op_sel_hi:[0,1,1]
    v_pk_mul_f16 v184, v228, v201 op_sel:[1,1] op_sel_hi:[1,0] neg_lo:[1,0]
    v_pk_fma_f16 v223, v228, v201, v184 op_sel:[0,0,0] op_sel_hi:[0,1,1]
    v_pk_mul_f16 v185, v229, v201 op_sel:[1,1] op_sel_hi:[1,0] neg_lo:[1,0]
    v_pk_fma_f16 v220, v229, v201, v185 op_sel:[0,0,0] op_sel_hi:[0,1,1]
    ds_read_b128 v[148:151], v168 offset:1504
    ds_write_addtid_b32 v218 offset:9504
    ds_write_addtid_b32 v226 offset:9792
    v_mfma_f32_16x16x32_f16 v[48:51], v[64:67], v[128:131], 0
    v_pk_mul_f16 v185, v101, v133 op_sel:[1,1] op_sel_hi:[1,0] neg_lo:[1,0]
    v_pk_fma_f16 v133, v101, v133, v185 op_sel:[0,0,0] op_sel_hi:[0,1,1]
    v_pk_mul_f16 v186, v230, v201 op_sel:[1,1] op_sel_hi:[1,0] neg_lo:[1,0]
    v_pk_fma_f16 v222, v230, v201, v186 op_sel:[0,0,0] op_sel_hi:[0,1,1]
    v_pk_mul_f16 v187, v179, v196 op_sel:[1,1] op_sel_hi:[1,0]
    v_pk_fma_f16 v206, v179, v196, v187 op_sel:[0,0,0] op_sel_hi:[0,1,1] neg_hi:[1,0,0]
    ds_read_b128 v[152:155], v168 offset:1568
    ds_read_b128 v[156:159], v168 offset:1632
    ds_write_addtid_b32 v224 offset:10080
    v_mfma_f32_16x16x32_f16 v[56:59], v[80:83], v[128:131], 0
    v_pk_mul_f16 v186, v102, v134 op_sel:[1,1] op_sel_hi:[1,0] neg_lo:[1,0]
    v_pk_fma_f16 v134, v102, v134, v186 op_sel:[0,0,0] op_sel_hi:[0,1,1]
    v_pk_mul_f16 v184, v206, v196 op_sel:[1,1] op_sel_hi:[1,0]
    v_pk_fma_f16 v207, v206, v196, v184 op_sel:[0,0,0] op_sel_hi:[0,1,1] neg_hi:[1,0,0]
    v_pk_mul_f16 v185, v207, v196 op_sel:[1,1] op_sel_hi:[1,0]
    v_pk_fma_f16 v208, v207, v196, v185 op_sel:[0,0,0] op_sel_hi:[0,1,1] neg_hi:[1,0,0]
    s_waitcnt lgkmcnt(15)
    s_nop 0
    ds_write_addtid_b32 v225 offset:10368
    ds_write_addtid_b32 v223 offset:10656
    ds_write_addtid_b32 v220 offset:10944
    v_mfma_f32_16x16x32_f16 v[52:55], v[84:87], v[100:103], v[52:55]
    v_pk_mul_f16 v187, v103, v135 op_sel:[1,1] op_sel_hi:[1,0] neg_lo:[1,0]
    v_pk_fma_f16 v135, v103, v135, v187 op_sel:[0,0,0] op_sel_hi:[0,1,1]
    v_pk_mul_f16 v186, v179, v197 op_sel:[1,1] op_sel_hi:[1,0]
    v_pk_fma_f16 v209, v179, v197, v186 op_sel:[0,0,0] op_sel_hi:[0,1,1] neg_hi:[1,0,0]
    v_pk_mul_f16 v187, v206, v197 op_sel:[1,1] op_sel_hi:[1,0]
    v_pk_fma_f16 v210, v206, v197, v187 op_sel:[0,0,0] op_sel_hi:[0,1,1] neg_hi:[1,0,0]
    ds_write_addtid_b32 v222 offset:11232
    ds_write_addtid_b32 v179 offset:1152
    ds_write_addtid_b32 v206 offset:0
    v_mfma_f32_16x16x32_f16 v[52:55], v[88:91], v[104:107], v[52:55]
    v_pk_mul_f16 v184, v104, v136 op_sel:[1,1] op_sel_hi:[1,0] neg_lo:[1,0]
    v_pk_fma_f16 v136, v104, v136, v184 op_sel:[0,0,0] op_sel_hi:[0,1,1]
    v_pk_mul_f16 v184, v207, v197 op_sel:[1,1] op_sel_hi:[1,0]
    v_pk_fma_f16 v211, v207, v197, v184 op_sel:[0,0,0] op_sel_hi:[0,1,1] neg_hi:[1,0,0]
    v_pk_mul_f16 v185, v208, v197 op_sel:[1,1] op_sel_hi:[1,0]
    v_pk_fma_f16 v212, v208, v197, v185 op_sel:[0,0,0] op_sel_hi:[0,1,1] neg_hi:[1,0,0]
    ds_read_b128 v[112:115], v169 offset:6912
    ds_write_addtid_b32 v207 offset:1728
    ds_write_addtid_b32 v208 offset:288
    v_mfma_f32_16x16x32_f16 v[48:51], v[68:71], v[132:135], v[48:51]
    v_pk_mul_f16 v185, v105, v137 op_sel:[1,1] op_sel_hi:[1,0] neg_lo:[1,0]
    v_pk_fma_f16 v137, v105, v137, v185 op_sel:[0,0,0] op_sel_hi:[0,1,1]
    v_pk_mul_f16 v186, v179, v198 op_sel:[1,1] op_sel_hi:[1,0]
    v_pk_fma_f16 v221, v179, v198, v186 op_sel:[0,0,0] op_sel_hi:[0,1,1] neg_hi:[1,0,0]
    v_pk_mul_f16 v187, v179, v203 op_sel:[1,1] op_sel_hi:[1,0]
    v_pk_fma_f16 v213, v179, v203, v187 op_sel:[0,0,0] op_sel_hi:[0,1,1] neg_hi:[1,0,0]
    ds_write_addtid_b32 v209 offset:2880
    ds_read_b128 v[116:119], v169 offset:6976
    ds_write_addtid_b32 v210 offset:2304
    v_mfma_f32_16x16x32_f16 v[56:59], v[84:87], v[132:135], v[56:59]
    v_pk_mul_f16 v186, v106, v138 op_sel:[1,1] op_sel_hi:[1,0] neg_lo:[1,0]
    v_pk_fma_f16 v138, v106, v138, v186 op_sel:[0,0,0] op_sel_hi:[0,1,1]
    v_pk_mul_f16 v184, v207, v203 op_sel:[1,1] op_sel_hi:[1,0]
    v_pk_fma_f16 v214, v207, v203, v184 op_sel:[0,0,0] op_sel_hi:[0,1,1] neg_hi:[1,0,0]
    v_pk_mul_f16 v185, v209, v203 op_sel:[1,1] op_sel_hi:[1,0]
    v_pk_fma_f16 v215, v209, v203, v185 op_sel:[0,0,0] op_sel_hi:[0,1,1] neg_hi:[1,0,0]
    s_waitcnt lgkmcnt(15)
    s_nop 0
    ds_read_b128 v[120:123], v169 offset:7040
    ds_read_b128 v[124:127], v169 offset:7104
    ds_write_addtid_b32 v211 offset:3456
    ds_write_addtid_b32 v212 offset:2016
    v_mfma_f32_16x16x32_f16 v[52:55], v[92:95], v[108:111], v[52:55]
    v_pk_mul_f16 v187, v107, v139 op_sel:[1,1] op_sel_hi:[1,0] neg_lo:[1,0]
    v_pk_fma_f16 v139, v107, v139, v187 op_sel:[0,0,0] op_sel_hi:[0,1,1]
    v_pk_mul_f16 v184, v108, v140 op_sel:[1,1] op_sel_hi:[1,0] neg_lo:[1,0]
    v_pk_fma_f16 v140, v108, v140, v184 op_sel:[0,0,0] op_sel_hi:[0,1,1]
    v_pk_mul_f16 v186, v211, v203 op_sel:[1,1] op_sel_hi:[1,0]
    v_pk_fma_f16 v216, v211, v203, v186 op_sel:[0,0,0] op_sel_hi:[0,1,1] neg_hi:[1,0,0]
    ds_write_addtid_b32 v221 offset:4608
    ds_write_addtid_b32 v213 offset:4032
    s_setprio 1
    s_nop 0
    v_mfma_f32_16x16x32_f16 v[48:51], v[72:75], v[136:139], v[48:51]
    v_pk_mul_f16 v185, v109, v141 op_sel:[1,1] op_sel_hi:[1,0] neg_lo:[1,0]
    v_pk_fma_f16 v141, v109, v141, v185 op_sel:[0,0,0] op_sel_hi:[0,1,1]
    v_pk_mul_f16 v186, v110, v142 op_sel:[1,1] op_sel_hi:[1,0] neg_lo:[1,0]
    v_pk_fma_f16 v142, v110, v142, v186 op_sel:[0,0,0] op_sel_hi:[0,1,1]
    v_pk_mul_f16 v187, v221, v203 op_sel:[1,1] op_sel_hi:[1,0]
    v_pk_fma_f16 v217, v221, v203, v187 op_sel:[0,0,0] op_sel_hi:[0,1,1] neg_hi:[1,0,0]
    ds_write_addtid_b32 v214 offset:864
    ds_write_addtid_b32 v215 offset:3744
    ds_write_addtid_b32 v216 offset:576
    v_mfma_f32_16x16x32_f16 v[56:59], v[88:91], v[136:139], v[56:59]
    v_pk_mul_f16 v187, v111, v143 op_sel:[1,1] op_sel_hi:[1,0] neg_lo:[1,0]
    v_pk_fma_f16 v143, v111, v143, v187 op_sel:[0,0,0] op_sel_hi:[0,1,1]
    v_pk_mul_f16 v184, v209, v204 op_sel:[1,1] op_sel_hi:[1,0]
    v_pk_fma_f16 v218, v209, v204, v184 op_sel:[0,0,0] op_sel_hi:[0,1,1] neg_hi:[1,0,0]
    v_pk_mul_f16 v185, v221, v204 op_sel:[1,1] op_sel_hi:[1,0]
    v_pk_fma_f16 v219, v221, v204, v185 op_sel:[0,0,0] op_sel_hi:[0,1,1] neg_hi:[1,0,0]
    ds_write_addtid_b32 v217 offset:4320
    ds_write_addtid_b32 v218 offset:3168
    ds_write_addtid_b32 v219 offset:2592
    v_mfma_f32_16x16x32_f16 v[48:51], v[76:79], v[140:143], v[48:51]
    v_pk_mul_f16 v186, v215, v204 op_sel:[1,1] op_sel_hi:[1,0]
    v_pk_fma_f16 v226, v215, v204, v186 op_sel:[0,0,0] op_sel_hi:[0,1,1] neg_hi:[1,0,0]
    v_pk_mul_f16 v187, v217, v204 op_sel:[1,1] op_sel_hi:[1,0]
    v_pk_fma_f16 v222, v217, v204, v187 op_sel:[0,0,0] op_sel_hi:[0,1,1] neg_hi:[1,0,0]
    v_pk_mul_f16 v184, v219, v204 op_sel:[1,1] op_sel_hi:[1,0]
    v_pk_fma_f16 v220, v219, v204, v184 op_sel:[0,0,0] op_sel_hi:[0,1,1] neg_hi:[1,0,0]
    ds_write_addtid_b32 v226 offset:5184
    ds_write_addtid_b32 v222 offset:6624
    ds_write_addtid_b32 v220 offset:6336
    v_mfma_f32_16x16x32_f16 v[56:59], v[92:95], v[140:143], v[56:59]
    s_bitcmp1_b32 s2, 3
    s_cbranch_scc0 L_sk1
    v_pk_mul_f16 v185, v222, v204 op_sel:[1,1] op_sel_hi:[1,0]
    v_pk_fma_f16 v223, v222, v204, v185 op_sel:[0,0,0] op_sel_hi:[0,1,1] neg_hi:[1,0,0]
    v_pk_mul_f16 v186, v220, v204 op_sel:[1,1] op_sel_hi:[1,0]
    v_pk_fma_f16 v224, v220, v204, v186 op_sel:[0,0,0] op_sel_hi:[0,1,1] neg_hi:[1,0,0]
    v_pk_mul_f16 v187, v223, v204 op_sel:[1,1] op_sel_hi:[1,0]
    v_pk_fma_f16 v225, v223, v204, v187 op_sel:[0,0,0] op_sel_hi:[0,1,1] neg_hi:[1,0,0]
    ds_write_addtid_b32 v223 offset:5472
    ds_write_addtid_b32 v224 offset:4896
    ds_write_addtid_b32 v225 offset:6048
L_sk1:
    s_waitcnt lgkmcnt(13)
    s_nop 0
    v_pk_mul_f16 v184, v112, v144 op_sel:[1,1] op_sel_hi:[1,0] neg_lo:[1,0]
    v_pk_fma_f16 v144, v112, v144, v184 op_sel:[0,0,0] op_sel_hi:[0,1,1]
    v_pk_mul_f16 v185, v113, v145 op_sel:[1,1] op_sel_hi:[1,0] neg_lo:[1,0]
    v_pk_fma_f16 v145, v113, v145, v185 op_sel:[0,0,0] op_sel_hi:[0,1,1]
    v_pk_mul_f16 v186, v114, v146 op_sel:[1,1] op_sel_hi:[1,0] neg_lo:[1,0]
    v_pk_fma_f16 v146, v114, v146, v186 op_sel:[0,0,0] op_sel_hi:[0,1,1]
    v_pk_mul_f16 v187, v115, v147 op_sel:[1,1] op_sel_hi:[1,0] neg_lo:[1,0]
    v_pk_fma_f16 v147, v115, v147, v187 op_sel:[0,0,0] op_sel_hi:[0,1,1]
    ds_read_b128 v[64:67], v170 offset:0
    ds_read_b128 v[68:71], v170 offset:64
    v_pk_mul_f16 v184, v116, v148 op_sel:[1,1] op_sel_hi:[1,0] neg_lo:[1,0]
    v_pk_fma_f16 v148, v116, v148, v184 op_sel:[0,0,0] op_sel_hi:[0,1,1]
    v_pk_mul_f16 v185, v117, v149 op_sel:[1,1] op_sel_hi:[1,0] neg_lo:[1,0]
    v_pk_fma_f16 v149, v117, v149, v185 op_sel:[0,0,0] op_sel_hi:[0,1,1]
    v_pk_mul_f16 v186, v118, v150 op_sel:[1,1] op_sel_hi:[1,0] neg_lo:[1,0]
    v_pk_fma_f16 v150, v118, v150, v186 op_sel:[0,0,0] op_sel_hi:[0,1,1]
    v_pk_mul_f16 v187, v119, v151 op_sel:[1,1] op_sel_hi:[1,0] neg_lo:[1,0]
    v_pk_fma_f16 v151, v119, v151, v187 op_sel:[0,0,0] op_sel_hi:[0,1,1]
    ds_read_b128 v[72:75], v170 offset:128
    ds_read_b128 v[76:79], v170 offset:192
    s_waitcnt lgkmcnt(3)
    v_mfma_f32_16x16x32_f16 v[44:47], v[64:67], v[112:115], v[44:47]
    ds_read_b128 v[80:83], v171 offset:2304
    v_pk_mul_f16 v184, v120, v152 op_sel:[1,1] op_sel_hi:[1,0] neg_lo:[1,0]
    v_pk_fma_f16 v152, v120, v152, v184 op_sel:[0,0,0] op_sel_hi:[0,1,1]
    s_waitcnt lgkmcnt(3)
    v_mfma_f32_16x16x32_f16 v[44:47], v[68:71], v[116:119], v[44:47]
    ds_read_b128 v[84:87], v171 offset:2368
    v_pk_mul_f16 v185, v121, v153 op_sel:[1,1] op_sel_hi:[1,0] neg_lo:[1,0]
    v_pk_fma_f16 v153, v121, v153, v185 op_sel:[0,0,0] op_sel_hi:[0,1,1]
    s_waitcnt lgkmcnt(3)
    v_mfma_f32_16x16x32_f16 v[44:47], v[72:75], v[120:123], v[44:47]
    ds_read_b128 v[88:91], v171 offset:2432
    v_pk_mul_f16 v186, v122, v154 op_sel:[1,1] op_sel_hi:[1,0] neg_lo:[1,0]
    v_pk_fma_f16 v154, v122, v154, v186 op_sel:[0,0,0] op_sel_hi:[0,1,1]
    s_waitcnt lgkmcnt(3)
    v_mfma_f32_16x16x32_f16 v[44:47], v[76:79], v[124:127], v[44:47]
    ds_read_b128 v[92:95], v171 offset:2496
    v_pk_mul_f16 v187, v123, v155 op_sel:[1,1] op_sel_hi:[1,0] neg_lo:[1,0]
    v_pk_fma_f16 v155, v123, v155, v187 op_sel:[0,0,0] op_sel_hi:[0,1,1]
    s_waitcnt lgkmcnt(3)
    v_mfma_f32_16x16x32_f16 v[52:55], v[80:83], v[112:115], v[52:55]
    v_pk_mul_f16 v184, v124, v156 op_sel:[1,1] op_sel_hi:[1,0] neg_lo:[1,0]
    v_pk_fma_f16 v156, v124, v156, v184 op_sel:[0,0,0] op_sel_hi:[0,1,1]
    s_waitcnt lgkmcnt(2)
    v_mfma_f32_16x16x32_f16 v[52:55], v[84:87], v[116:119], v[52:55]
    v_pk_mul_f16 v185, v125, v157 op_sel:[1,1] op_sel_hi:[1,0] neg_lo:[1,0]
    v_pk_fma_f16 v157, v125, v157, v185 op_sel:[0,0,0] op_sel_hi:[0,1,1]
    s_waitcnt vmcnt(1)
    s_mov_b32 m0, s54
    s_waitcnt lgkmcnt(1)
    v_mfma_f32_16x16x32_f16 v[52:55], v[88:91], v[120:123], v[52:55]
    v_perm_b32 v96, v8, v4, s38
    v_perm_b32 v97, v8, v4, s39
    s_waitcnt lgkmcnt(0)
    v_mfma_f32_16x16x32_f16 v[52:55], v[92:95], v[124:127], v[52:55]
    ds_write_addtid_b32 v96 offset:0
    v_perm_b32 v98, v9, v5, s38
    v_perm_b32 v99, v9, v5, s39
    v_mfma_f32_16x16x32_f16 v[48:51], v[64:67], v[144:147], v[48:51]
    ds_write_addtid_b32 v97 offset:4608
    v_perm_b32 v100, v10, v6, s38
    v_perm_b32 v101, v10, v6, s39
    v_mfma_f32_16x16x32_f16 v[56:59], v[80:83], v[144:147], v[56:59]
    ds_write_addtid_b32 v98 offset:9216
    v_perm_b32 v102, v11, v7, s38
    v_perm_b32 v103, v11, v7, s39
    buffer_load_dwordx4 v[12:15], v172, s[56:59], s53 offen
    buffer_load_dwordx4 v[16:19], v172, s[56:59], s53 offen offset:1024
    v_mfma_f32_16x16x32_f16 v[48:51], v[68:71], v[148:151], v[48:51]
    ds_write_addtid_b32 v99 offset:13824
    v_pk_mul_f16 v186, v126, v158 op_sel:[1,1] op_sel_hi:[1,0] neg_lo:[1,0]
    v_pk_fma_f16 v158, v126, v158, v186 op_sel:[0,0,0] op_sel_hi:[0,1,1]
    v_mfma_f32_16x16x32_f16 v[56:59], v[84:87], v[148:151], v[56:59]
    ds_write_addtid_b32 v100 offset:18432
    v_pk_mul_f16 v187, v127, v159 op_sel:[1,1] op_sel_hi:[1,0] neg_lo:[1,0]
    v_pk_fma_f16 v159, v127, v159, v187 op_sel:[0,0,0] op_sel_hi:[0,1,1]
    v_mfma_f32_16x16x32_f16 v[48:51], v[72:75], v[152:155], v[48:51]
    ds_write_addtid_b32 v101 offset:23040
    v_mfma_f32_16x16x32_f16 v[56:59], v[88:91], v[152:155], v[56:59]
    ds_write_addtid_b32 v102 offset:27648
    v_mfma_f32_16x16x32_f16 v[48:51], v[76:79], v[156:159], v[48:51]
    ds_write_addtid_b32 v103 offset:32256
    s_setprio 0
    v_mfma_f32_16x16x32_f16 v[56:59], v[92:95], v[156:159], v[56:59]
    v_fma_f32 v44, v44, v160, v161
    v_mul_f32 v45, v160, v45
    v_mul_f32 v46, v160, v46
    v_mul_f32 v47, v160, v47
    v_cvt_pk_bf16_f32 v128, v45, v44
    v_cvt_pk_bf16_f32 v129, v46, v45
    v_mul_f32 v52, v160, v52
    v_cvt_pk_bf16_f32 v130, v47, v46
    v_cvt_pk_bf16_f32 v131, v52, v47
    v_mul_f32 v53, v160, v53
    v_mul_f32 v54, v160, v54
    v_mul_f32 v55, v160, v55
    ds_write_b128 v43, v[128:131] offset:256
    v_cvt_pk_bf16_f32 v136, v53, v54
    s_mov_b64 exec, 1
    v_lshrrev_b32 v63, 16, v128
    s_mov_b64 exec, -1
    v_mul_f32 v48, v160, v48
    v_mul_f32 v49, v160, v49
    v_mul_f32 v50, v160, v50
    v_mul_f32 v51, v160, v51
    v_cvt_pk_bf16_f32 v132, v49, v48
    v_cvt_pk_bf16_f32 v133, v50, v49
    v_mul_f32 v56, v160, v56
    v_cvt_pk_bf16_f32 v134, v51, v50
    v_cvt_pk_bf16_f32 v135, v56, v51
    v_mul_f32 v57, v160, v57
    ds_write_b128 v43, v[132:135] offset:768
    v_mul_f32 v58, v160, v58
    v_mul_f32 v59, v160, v59
    v_cvt_pk_bf16_f32 v137, v57, v58
    v_cvt_pk_bf16_f32 v138, v55, v59
    s_brev_b32 exec_lo, 1
    s_brev_b32 exec_hi, 1
    v_and_b32 v62, s51, v137
    v_lshrrev_b32 v60, v167, v137
    v_or_b32 v61, v60, v62
    s_mov_b64 exec, -1
    ds_write2_b32 v165, v136, v137 offset0:0 offset1:16
    ds_write_b16 v166, v138 offset:3456
    ds_write_b16_d16_hi v166, v138 offset:3488
    ds_write_b128 v163, v[60:63] offset:240
    s_cbranch_vccnz L_slow
L_back_lo:
L_back_hi:
    s_bitcmp1_b32 s2, 3
    s_waitcnt lgkmcnt(6)
    s_cbranch_scc1 L_hi
    ds_read2_b32 v[44:45], v2 offset0:230 offset1:224
    ds_read2_b32 v[48:49], v2 offset0:198 offset1:192
    ds_read2_b32 v[52:53], v2 offset0:166 offset1:160
    ds_read2_b32 v[54:55], v2 offset0:164 offset1:162
    s_barrier
    s_mov_b32 s62, 0x400000
    ds_read_b128 v[56:59], v1 offset:480
    ds_read_b128 v[60:63], v1 offset:464
    ds_read_b128 v[64:67], v1 offset:544
    ds_read_b128 v[68:71], v1 offset:992
    ds_read_b128 v[72:75], v1 offset:32
    ds_read_b128 v[76:79], v1 offset:608
    s_waitcnt lgkmcnt(5)
    v_mfma_f32_16x16x32_bf16 v[80:83], v[56:59], v[20:23], 0
    s_setprio 3
    ds_read_b128 v[84:87], v1 offset:976
    v_mfma_f32_16x16x32_bf16 v[88:91], v[56:59], v[24:27], 0
    s_waitcnt lgkmcnt(4)
    ds_read_b128 v[92:95], v1 offset:96
    v_mfma_f32_16x16x32_bf16 v[96:99], v[60:63], v[20:23], 0
    ds_read_b128 v[100:103], v1 offset:672
    v_mfma_f32_16x16x32_bf16 v[104:107], v[60:63], v[24:27], 0
    ds_read2_b32 v[112:113], v2 offset0:134 offset1:128
    v_mov_b32_dpp v46, v44 row_shr:2 row_mask:0xf bank_mask:0xf
    v_mov_b32_dpp v47, v44 row_shr:4 row_mask:0xf bank_mask:0xf
    s_nop 0
    v_mov_b32_dpp v46, v45 row_shl:4 row_mask:0xf bank_mask:0xf
    v_mov_b32_dpp v47, v45 row_shl:2 row_mask:0xf bank_mask:0xf
    s_nop 1
    v_mfma_f32_16x16x32_bf16 v[116:119], v[44:47], v[64:67], 0
    s_waitcnt lgkmcnt(5)
    ds_read_b128 v[120:123], v1 offset:160
    v_mov_b32_dpp v50, v48 row_shr:2 row_mask:0xf bank_mask:0xf
    v_mov_b32_dpp v51, v48 row_shr:4 row_mask:0xf bank_mask:0xf
    v_mfma_f32_16x16x32_bf16 v[124:127], v[68:71], v[20:23], 0
    ds_read_b128 v[128:131], v1 offset:736
    v_mov_b32_dpp v50, v49 row_shl:4 row_mask:0xf bank_mask:0xf
    v_mov_b32_dpp v51, v49 row_shl:2 row_mask:0xf bank_mask:0xf
    v_mfma_f32_16x16x32_bf16 v[132:135], v[44:47], v[72:75], 0
    s_waitcnt lgkmcnt(2)
    ds_read2_b32 v[136:137], v2 offset0:102 offset1:96
    v_mov_b32_dpp v114, v112 row_shr:2 row_mask:0xf bank_mask:0xf
    v_mov_b32_dpp v115, v112 row_shr:4 row_mask:0xf bank_mask:0xf
    v_mfma_f32_16x16x32_bf16 v[140:143], v[68:71], v[24:27], 0
    s_setprio 1
    ds_read_b128 v[144:147], v1 offset:224
    v_mov_b32_dpp v114, v113 row_shl:4 row_mask:0xf bank_mask:0xf
    v_mov_b32_dpp v115, v113 row_shl:2 row_mask:0xf bank_mask:0xf
    v_mfma_f32_16x16x32_bf16 v[116:119], v[48:51], v[76:79], v[116:119]
    ds_read_b128 v[148:151], v1 offset:800
    v_cvt_pk_bf16_f32 v60, v80, v88
    v_cvt_pk_bf16_f32 v61, v96, v104
    v_mfma_f32_16x16x32_bf16 v[152:155], v[84:87], v[20:23], 0
    s_setprio 1
    s_waitcnt lgkmcnt(2)
    ds_read_b128 v[156:159], v1 offset:288
    v_mov_b32_dpp v138, v136 row_shr:2 row_mask:0xf bank_mask:0xf
    v_mov_b32_dpp v139, v136 row_shr:4 row_mask:0xf bank_mask:0xf
    v_mfma_f32_16x16x32_bf16 v[132:135], v[48:51], v[92:95], v[132:135]
    ds_read2_b32 v[160:161], v2 offset0:70 offset1:64
    v_mov_b32_dpp v138, v137 row_shl:4 row_mask:0xf bank_mask:0xf
    v_mov_b32_dpp v139, v137 row_shl:2 row_mask:0xf bank_mask:0xf
    v_mfma_f32_16x16x32_bf16 v[164:167], v[84:87], v[24:27], 0
    ds_read2_b32 v[162:163], v2 offset0:68 offset1:66
    v_cvt_pk_bf16_f32 v62, v81, v89
    v_cvt_pk_bf16_f32 v63, v97, v105
    v_mfma_f32_16x16x32_bf16 v[116:119], v[52:55], v[100:103], v[116:119]
    ds_read_b128 v[172:175], v1 offset:864
    v_cvt_pk_bf16_f32 v108, v82, v90
    v_cvt_pk_bf16_f32 v109, v98, v106
    v_mfma_f32_16x16x32_bf16 v[132:135], v[52:55], v[120:123], v[132:135]
    s_setprio 0
    ds_read2_b32 v[176:177], v2 offset0:38 offset1:32
    v_cvt_pk_bf16_f32 v110, v83, v91
    v_cvt_pk_bf16_f32 v111, v99, v107
    v_mfma_f32_16x16x32_bf16 v[116:119], v[112:115], v[128:131], v[116:119]
    s_waitcnt lgkmcnt(4)
    ds_read_b128 v[80:83], v1 offset:352
    v_cvt_pk_bf16_f32 v84, v124, v140
    v_cvt_pk_bf16_f32 v85, v152, v164
    v_mfma_f32_16x16x32_bf16 v[132:135], v[112:115], v[144:147], v[132:135]
    ds_read_b128 v[88:91], v1 offset:928
    v_cvt_pk_bf16_f32 v86, v125, v141
    v_cvt_pk_bf16_f32 v87, v153, v165
    v_mfma_f32_16x16x32_bf16 v[116:119], v[136:139], v[148:151], v[116:119]
    s_waitcnt lgkmcnt(2)
    ds_read2_b32 v[96:97], v2 offset0:6 offset1:0
    v_mov_b32_dpp v178, v176 row_shr:2 row_mask:0xf bank_mask:0xf
    v_mov_b32_dpp v179, v176 row_shr:4 row_mask:0xf bank_mask:0xf
    v_mfma_f32_16x16x32_bf16 v[132:135], v[136:139], v[156:159], v[132:135]
    ds_read_b128 v[104:107], v1 offset:416
    v_mov_b32_dpp v178, v177 row_shl:4 row_mask:0xf bank_mask:0xf
    v_mov_b32_dpp v179, v177 row_shl:2 row_mask:0xf bank_mask:0xf
    v_mfma_f32_16x16x32_bf16 v[116:119], v[160:163], v[172:175], v[116:119]
    s_waitcnt lgkmcnt(2)
    ds_read2_b32 v[180:181], v36 offset0:230 offset1:224
    v_cvt_pk_bf16_f32 v168, v126, v142
    v_cvt_pk_bf16_f32 v169, v154, v166
    v_mfma_f32_16x16x32_bf16 v[132:135], v[160:163], v[80:83], v[132:135]
    s_waitcnt lgkmcnt(2)
    ds_read2_b32 v[184:185], v36 offset0:166 offset1:160
    v_mov_b32_dpp v98, v96 row_shr:2 row_mask:0xf bank_mask:0xf
    v_mov_b32_dpp v99, v96 row_shr:4 row_mask:0xf bank_mask:0xf
    v_mfma_f32_16x16x32_bf16 v[116:119], v[176:179], v[88:91], v[116:119]
    s_waitcnt lgkmcnt(2)
    ds_read2_b32 v[188:189], v36 offset0:198 offset1:192
    v_mov_b32_dpp v98, v97 row_shl:4 row_mask:0xf bank_mask:0xf
    v_mov_b32_dpp v99, v97 row_shl:2 row_mask:0xf bank_mask:0xf
    v_mfma_f32_16x16x32_bf16 v[132:135], v[176:179], v[104:107], v[132:135]
    s_waitcnt lgkmcnt(2)
    ds_read2_b32 v[190:191], v36 offset0:196 offset1:194
    v_mov_b32_dpp v182, v180 row_shr:2 row_mask:0xf bank_mask:0xf
    v_mov_b32_dpp v183, v180 row_shr:4 row_mask:0xf bank_mask:0xf
    v_mfma_f32_16x16x32_bf16 v[116:119], v[96:99], v[68:71], v[116:119]
    ds_read2_b32 v[192:193], v36 offset0:134 offset1:128
    v_mov_b32_dpp v182, v181 row_shl:4 row_mask:0xf bank_mask:0xf
    v_mov_b32_dpp v183, v181 row_shl:2 row_mask:0xf bank_mask:0xf
    v_mfma_f32_16x16x32_bf16 v[132:135], v[96:99], v[56:59], v[132:135]
    s_waitcnt lgkmcnt(3)
    ds_read2_b32 v[194:195], v36 offset0:132 offset1:130
    v_mov_b32_dpp v186, v184 row_shr:2 row_mask:0xf bank_mask:0xf
    v_mov_b32_dpp v187, v184 row_shr:4 row_mask:0xf bank_mask:0xf
    v_mfma_f32_16x16x32_bf16 v[116:119], v[180:183], v[72:75], v[116:119]
    s_waitcnt lgkmcnt(2)
    ds_read2_b32 v[72:73], v36 offset0:102 offset1:96
    v_mov_b32_dpp v186, v185 row_shl:4 row_mask:0xf bank_mask:0xf
    v_mov_b32_dpp v187, v185 row_shl:2 row_mask:0xf bank_mask:0xf
    v_mfma_f32_16x16x32_bf16 v[116:119], v[188:191], v[92:95], v[116:119]
    ds_read2_b32 v[74:75], v36 offset0:100 offset1:98
    v_cvt_pk_bf16_f32 v170, v127, v143
    v_cvt_pk_bf16_f32 v4, v132, v133
    v_mfma_f32_16x16x32_bf16 v[116:119], v[184:187], v[120:123], v[116:119]
    s_waitcnt lgkmcnt(2)
    ds_read2_b32 v[92:93], v36 offset0:70 offset1:64
    v_cvt_pk_bf16_f32 v5, v134, v135
    v_cvt_pk_bf16_f32 v171, v155, v167
    v_mfma_f32_16x16x32_bf16 v[116:119], v[192:195], v[144:147], v[116:119]
    ds_write_b64 v39, v[4:5] offset:6976
    s_waitcnt lgkmcnt(2)
    v_mfma_f32_16x16x32_bf16 v[116:119], v[72:75], v[156:159], v[116:119]
    ds_read2_b32 v[94:95], v36 offset0:68 offset1:66
    v_mfma_f32_16x16x32_bf16 v[120:123], v[180:183], v[64:67], 0
    ds_read2_b32 v[64:65], v36 offset0:38 offset1:32
    v_mfma_f32_16x16x32_bf16 v[120:123], v[188:191], v[76:79], v[120:123]
    ds_read2_b32 v[66:67], v36 offset0:36 offset1:34
    s_waitcnt lgkmcnt(3)
    s_barrier
    s_waitcnt lgkmcnt(2)
    v_mfma_f32_16x16x32_bf16 v[116:119], v[92:95], v[80:83], v[116:119]
    s_nop 0
    ds_read_b64_tr_b16 v[6:7], v40 offset:0
    ds_read2_b32 v[76:77], v36 offset0:6 offset1:0
    v_mfma_f32_16x16x32_bf16 v[120:123], v[184:187], v[100:103], v[120:123]
    s_setprio 3
    s_waitcnt lgkmcnt(2)
    ds_read_b64_tr_b16 v[8:9], v40 offset:46336
    s_add_u32 s48, s34, 0
    ds_read2_b32 v[78:79], v36 offset0:4 offset1:2
    v_mfma_f32_16x16x32_bf16 v[116:119], v[64:67], v[104:107], v[116:119]
    ds_read2_b32 v[80:81], v3 offset0:6 offset1:0
    v_mfma_f32_16x16x32_bf16 v[120:123], v[192:195], v[128:131], v[120:123]
    s_setprio 3
    ds_read2_b32 v[82:83], v3 offset0:4 offset1:2
    s_mov_b64 exec, s[26:27]
    s_waitcnt lgkmcnt(3)
    buffer_store_dwordx4 v[6:9], v41, s[60:63], s48 offen
    s_mov_b64 exec, -1
    s_waitcnt lgkmcnt(2)
    v_mfma_f32_16x16x32_bf16 v[116:119], v[76:79], v[56:59], v[116:119]
    s_setprio 1
    ds_read_b64 v[100:101], v37 offset:3072
    v_mfma_f32_16x16x32_bf16 v[120:123], v[72:75], v[148:151], v[120:123]
    ds_read_b64 v[102:103], v37 offset:3064
    s_nop 1
    s_waitcnt lgkmcnt(2)
    v_mfma_f32_16x16x32_bf16 v[120:123], v[80:83], v[56:59], v[120:123]
    s_setprio 2
    ds_read_b64 v[104:105], v37 offset:3056
    v_mfma_f32_16x16x32_bf16 v[120:123], v[92:95], v[172:175], v[120:123]
    s_setprio 2
    ds_read_b64 v[106:107], v37 offset:3048
    v_cvt_pk_bf16_f32 v4, v116, v117
    v_cvt_pk_bf16_f32 v5, v118, v119
    s_waitcnt lgkmcnt(2)
    v_mfma_f32_16x16x32_bf16 v[120:123], v[60:63], v[100:103], v[120:123]
    s_setprio 1
    ds_write_b64 v39, v[4:5] offset:7616
    v_mfma_f32_16x16x32_bf16 v[120:123], v[64:67], v[88:91], v[120:123]
    s_setprio 1
    ds_read_b128 v[88:91], v1 offset:1056
    s_waitcnt lgkmcnt(2)
    v_mfma_f32_16x16x32_bf16 v[120:123], v[108:111], v[104:107], v[120:123]
    s_setprio 0
    ds_read_b128 v[116:119], v1 offset:1120
    v_mfma_f32_16x16x32_bf16 v[124:127], v[80:83], v[68:71], 0
    ds_read_b128 v[128:131], v1 offset:1184
    s_waitcnt lgkmcnt(3)
    s_barrier
    v_mfma_f32_16x16x32_bf16 v[120:123], v[76:79], v[68:71], v[120:123]
    s_setprio 1
    s_waitcnt lgkmcnt(2)
    ds_read_b64_tr_b16 v[6:7], v40 offset:640
    ds_read_b128 v[68:71], v1 offset:1248
    v_mfma_f32_16x16x32_bf16 v[120:123], v[44:47], v[88:91], v[120:123]
    s_waitcnt lgkmcnt(2)
    ds_read_b64_tr_b16 v[8:9], v40 offset:46976
    s_add_u32 s48, s34, 524288
    v_mfma_f32_16x16x32_bf16 v[120:123], v[48:51], v[116:119], v[120:123]
    ds_read_b128 v[132:135], v1 offset:1312
    v_mfma_f32_16x16x32_bf16 v[120:123], v[52:55], v[128:131], v[120:123]
    s_waitcnt lgkmcnt(2)
    ds_read_b128 v[140:143], v1 offset:1376
    s_mov_b64 exec, s[26:27]
    s_waitcnt lgkmcnt(2)
    buffer_store_dwordx4 v[6:9], v41, s[60:63], s48 offen
    s_mov_b64 exec, -1
    v_mfma_f32_16x16x32_bf16 v[120:123], v[112:115], v[68:71], v[120:123]
    s_setprio 0
    ds_read_b128 v[144:147], v1 offset:1440
    s_waitcnt lgkmcnt(2)
    v_mfma_f32_16x16x32_bf16 v[120:123], v[136:139], v[132:135], v[120:123]
    ds_read_b128 v[148:151], v1 offset:1504
    s_waitcnt lgkmcnt(2)
    v_mfma_f32_16x16x32_bf16 v[120:123], v[160:163], v[140:143], v[120:123]
    ds_read_b64 v[152:153], v37 offset:3200
    s_waitcnt lgkmcnt(2)
    v_mfma_f32_16x16x32_bf16 v[120:123], v[176:179], v[144:147], v[120:123]
    ds_read_b64 v[154:155], v37 offset:3192
    s_waitcnt lgkmcnt(2)
    v_mfma_f32_16x16x32_bf16 v[120:123], v[96:99], v[148:151], v[120:123]
    ds_read_b64 v[156:157], v37 offset:3184
    v_mfma_f32_16x16x32_bf16 v[124:127], v[180:183], v[88:91], v[124:127]
    ds_read_b64 v[158:159], v37 offset:3176
    s_nop 1
    v_mfma_f32_16x16x32_bf16 v[124:127], v[188:191], v[116:119], v[124:127]
    s_setprio 3
    ds_read_b128 v[88:91], v1 offset:1568
    s_nop 1
    v_mfma_f32_16x16x32_bf16 v[124:127], v[184:187], v[128:131], v[124:127]
    ds_read_b128 v[116:119], v1 offset:1632
    v_cvt_pk_bf16_f32 v4, v120, v121
    v_cvt_pk_bf16_f32 v5, v122, v123
    v_mfma_f32_16x16x32_bf16 v[124:127], v[192:195], v[68:71], v[124:127]
    s_waitcnt lgkmcnt(2)
    ds_write_b64 v39, v[4:5] offset:8256
    v_mfma_f32_16x16x32_bf16 v[124:127], v[60:63], v[152:155], v[124:127]
    ds_read_b128 v[68:71], v1 offset:1696
    v_mfma_f32_16x16x32_bf16 v[124:127], v[72:75], v[132:135], v[124:127]
    ds_read_b128 v[120:123], v1 offset:1760
    v_mfma_f32_16x16x32_bf16 v[124:127], v[108:111], v[156:159], v[124:127]
    ds_read_b128 v[128:131], v1 offset:1824
    s_waitcnt lgkmcnt(3)
    s_barrier
    v_mfma_f32_16x16x32_bf16 v[124:127], v[92:95], v[140:143], v[124:127]
    s_nop 0
    ds_read_b64_tr_b16 v[6:7], v40 offset:1280
    ds_read_b128 v[132:135], v1 offset:1888
    v_mfma_f32_16x16x32_bf16 v[124:127], v[44:47], v[88:91], v[124:127]
    ds_read_b64_tr_b16 v[8:9], v40 offset:47616
    s_add_u32 s48, s34, 1048576
    v_mfma_f32_16x16x32_bf16 v[124:127], v[64:67], v[144:147], v[124:127]
    ds_read_b128 v[140:143], v1 offset:1952
    v_mfma_f32_16x16x32_bf16 v[124:127], v[48:51], v[116:119], v[124:127]
    ds_read_b128 v[144:147], v1 offset:2016
    s_mov_b64 exec, s[26:27]
    s_waitcnt lgkmcnt(2)
    buffer_store_dwordx4 v[6:9], v41, s[60:63], s48 offen
    s_mov_b64 exec, -1
    v_mfma_f32_16x16x32_bf16 v[124:127], v[76:79], v[148:151], v[124:127]
    ds_read_b128 v[164:167], v1 offset:464
    v_mfma_f32_16x16x32_bf16 v[124:127], v[52:55], v[68:71], v[124:127]
    ds_read_b128 v[172:175], v1 offset:1488
    v_mfma_f32_16x16x32_bf16 v[124:127], v[112:115], v[120:123], v[124:127]
    ds_read2_b32 v[196:197], v3 offset0:132 offset1:126
    v_mfma_f32_16x16x32_bf16 v[124:127], v[136:139], v[128:131], v[124:127]
    s_setprio 1
    ds_read2_b32 v[198:199], v3 offset0:130 offset1:128
    v_mfma_f32_16x16x32_bf16 v[124:127], v[160:163], v[132:135], v[124:127]
    s_waitcnt lgkmcnt(4)
    ds_read_b64 v[200:201], v37 offset:3328
    v_mfma_f32_16x16x32_bf16 v[124:127], v[176:179], v[140:143], v[124:127]
    ds_read_b64 v[202:203], v37 offset:3320
    v_mfma_f32_16x16x32_bf16 v[124:127], v[96:99], v[144:147], v[124:127]
    ds_read_b64 v[204:205], v37 offset:3312
    s_cmp_lt_u32 s32, 2
    s_waitcnt vmcnt(3)
    s_cbranch_scc0 L_sC
    s_mov_b32 m0, s55
    v_perm_b32 v208, v16, v12, s38
    v_perm_b32 v209, v16, v12, s39
    v_perm_b32 v210, v17, v13, s38
    v_perm_b32 v211, v17, v13, s39
    ds_write_addtid_b32 v208 offset:0
    ds_write_addtid_b32 v209 offset:4608
    v_perm_b32 v212, v18, v14, s38
    v_perm_b32 v213, v18, v14, s39
    v_perm_b32 v214, v19, v15, s38
    v_perm_b32 v215, v19, v15, s39
    ds_write_addtid_b32 v210 offset:9216
    ds_write_addtid_b32 v211 offset:13824
    ds_write_addtid_b32 v212 offset:18432
    ds_write_addtid_b32 v213 offset:23040
    ds_write_addtid_b32 v214 offset:27648
    ds_write_addtid_b32 v215 offset:32256
L_sC:
    v_mfma_f32_16x16x32_bf16 v[124:127], v[84:87], v[100:103], v[124:127]
    ds_read_b64 v[206:207], v37 offset:3304
    v_mfma_f32_16x16x32_bf16 v[124:127], v[168:171], v[104:107], v[124:127]
    s_setprio 3
    ds_read2_b32 v[10:11], v38 offset0:3 offset1:0
    v_mfma_f32_16x16x32_bf16 v[14:17], v[56:59], v[28:31], 0
    s_waitcnt lgkmcnt(8)
    ds_read2_b32 v[12:13], v38 offset0:2 offset1:1
    v_mfma_f32_16x16x32_bf16 v[28:31], v[164:167], v[32:35], 0
    s_nop 2
    v_mfma_f32_16x16x32_bf16 v[164:167], v[180:183], v[88:91], 0
    s_setprio 0
    v_cvt_pk_bf16_f32 v4, v124, v125
    v_cvt_pk_bf16_f32 v5, v126, v127
    v_mfma_f32_16x16x32_bf16 v[164:167], v[84:87], v[152:155], v[164:167]
    ds_write_b64 v39, v[4:5] offset:8896
    v_cvt_pk_bf16_f32 v32, v14, v28
    v_cvt_pk_bf16_f32 v33, v17, v31
    v_mfma_f32_16x16x32_bf16 v[84:87], v[148:151], v[20:23], 0
    v_cvt_pk_bf16_f32 v34, v15, v29
    v_cvt_pk_bf16_f32 v35, v16, v30
    v_mfma_f32_16x16x32_bf16 v[164:167], v[168:171], v[156:159], v[164:167]
    v_mfma_f32_16x16x32_bf16 v[164:167], v[188:191], v[116:119], v[164:167]
    s_waitcnt lgkmcnt(0)
    s_barrier
    v_mfma_f32_16x16x32_bf16 v[14:17], v[148:151], v[24:27], 0
    s_nop 0
    ds_read_b64_tr_b16 v[6:7], v40 offset:1920
    ds_read_b128 v[28:31], v1 offset:2080
    v_mfma_f32_16x16x32_bf16 v[164:167], v[184:187], v[68:71], v[164:167]
    ds_read_b64_tr_b16 v[8:9], v40 offset:48256
    s_add_u32 s48, s34, 1572864
    v_mfma_f32_16x16x32_bf16 v[68:71], v[172:175], v[20:23], 0
    ds_read_b128 v[18:21], v1 offset:2144
    v_mfma_f32_16x16x32_bf16 v[164:167], v[192:195], v[120:123], v[164:167]
    s_setprio 3
    ds_read_b128 v[88:91], v1 offset:2208
    s_mov_b64 exec, s[26:27]
    s_waitcnt lgkmcnt(2)
    buffer_store_dwordx4 v[6:9], v41, s[60:63], s48 offen
    s_mov_b64 exec, -1
    v_mfma_f32_16x16x32_bf16 v[164:167], v[80:83], v[148:151], v[164:167]
    ds_read_b128 v[80:83], v1 offset:2272
    v_mfma_f32_16x16x32_bf16 v[116:119], v[172:175], v[24:27], 0
    ds_read_b128 v[124:127], v1 offset:2336
    v_mfma_f32_16x16x32_bf16 v[164:167], v[72:75], v[128:131], v[164:167]
    s_setprio 2
    ds_read_b128 v[72:75], v1 offset:2400
    v_mfma_f32_16x16x32_bf16 v[164:167], v[92:95], v[132:135], v[164:167]
    ds_read_b128 v[92:95], v1 offset:2464
    v_mfma_f32_16x16x32_bf16 v[164:167], v[196:199], v[56:59], v[164:167]
    ds_read_b128 v[56:59], v1 offset:2528
    v_mfma_f32_16x16x32_bf16 v[164:167], v[60:63], v[200:203], v[164:167]
    s_setprio 1
    v_cvt_pk_bf16_f32 v22, v84, v14
    v_cvt_pk_bf16_f32 v23, v68, v116
    v_mfma_f32_16x16x32_bf16 v[164:167], v[64:67], v[140:143], v[164:167]
    v_cvt_pk_bf16_f32 v24, v85, v15
    v_cvt_pk_bf16_f32 v25, v69, v117
    v_mfma_f32_16x16x32_bf16 v[164:167], v[108:111], v[204:207], v[164:167]
    v_cvt_pk_bf16_f32 v120, v86, v16
    v_cvt_pk_bf16_f32 v121, v70, v118
    v_mfma_f32_16x16x32_bf16 v[164:167], v[76:79], v[144:147], v[164:167]
    s_setprio 0
    v_cvt_pk_bf16_f32 v122, v87, v17
    v_cvt_pk_bf16_f32 v123, v71, v119
    v_mfma_f32_16x16x32_bf16 v[164:167], v[44:47], v[28:31], v[164:167]
    s_waitcnt lgkmcnt(5)
    v_mfma_f32_16x16x32_bf16 v[164:167], v[48:51], v[18:21], v[164:167]
    v_mfma_f32_16x16x32_bf16 v[164:167], v[32:35], v[10:13], v[164:167]
    s_setprio 2
    v_mfma_f32_16x16x32_bf16 v[164:167], v[52:55], v[88:91], v[164:167]
    s_waitcnt lgkmcnt(2)
    v_mfma_f32_16x16x32_bf16 v[164:167], v[112:115], v[80:83], v[164:167]
    v_mfma_f32_16x16x32_bf16 v[164:167], v[136:139], v[124:127], v[164:167]
    s_setprio 3
    v_mfma_f32_16x16x32_bf16 v[164:167], v[160:163], v[72:75], v[164:167]
    s_waitcnt lgkmcnt(1)
    v_mfma_f32_16x16x32_bf16 v[164:167], v[176:179], v[92:95], v[164:167]
    s_waitcnt lgkmcnt(0)
    v_mfma_f32_16x16x32_bf16 v[164:167], v[96:99], v[56:59], v[164:167]
    v_mfma_f32_16x16x32_bf16 v[164:167], v[22:25], v[100:103], v[164:167]
    v_mfma_f32_16x16x32_bf16 v[164:167], v[120:123], v[104:107], v[164:167]
    s_nop 7
    v_cvt_pk_bf16_f32 v4, v164, v165
    v_cvt_pk_bf16_f32 v5, v166, v167
    ds_write_b64 v39, v[4:5] offset:9536
    s_waitcnt lgkmcnt(0)
    s_barrier
    ds_read_b64_tr_b16 v[6:7], v40 offset:2560
    ds_read_b64_tr_b16 v[8:9], v40 offset:48896
    s_add_u32 s48, s34, 2097152
    s_mov_b64 exec, s[26:27]
    s_waitcnt lgkmcnt(0)
    buffer_store_dwordx4 v[6:9], v41, s[60:63], s48 offen
    s_mov_b64 exec, -1
    s_endpgm
.p2align 12
L_hi:
    ds_read_b64 v[44:45], v37 offset:3328
    ds_read_b64 v[46:47], v37 offset:3320
    ds_read2_b32 v[48:49], v38 offset0:3 offset1:0
    ds_read2_b32 v[50:51], v38 offset0:2 offset1:1
    s_barrier
    s_mov_b32 s62, 0x400000
    ds_read_b128 v[52:55], v1 offset:992
    ds_read_b128 v[56:59], v1 offset:976
    s_waitcnt lgkmcnt(1)
    v_mfma_f32_16x16x32_bf16 v[60:63], v[52:55], v[28:31], 0
    ds_read_b128 v[64:67], v1 offset:480
    s_waitcnt lgkmcnt(1)
    v_mfma_f32_16x16x32_bf16 v[68:71], v[56:59], v[32:35], 0
    ds_read_b128 v[76:79], v1 offset:464
    s_waitcnt lgkmcnt(1)
    v_mfma_f32_16x16x32_bf16 v[80:83], v[64:67], v[28:31], 0
    s_setprio 0
    ds_read_b128 v[64:67], v1 offset:1504
    s_waitcnt lgkmcnt(1)
    v_mfma_f32_16x16x32_bf16 v[84:87], v[76:79], v[32:35], 0
    ds_read_b128 v[88:91], v1 offset:1488
    s_waitcnt lgkmcnt(1)
    v_mfma_f32_16x16x32_bf16 v[92:95], v[64:67], v[20:23], 0
    s_setprio 3
    ds_read_b128 v[96:99], v1 offset:2016
    v_cvt_pk_bf16_f32 v72, v60, v68
    v_cvt_pk_bf16_f32 v73, v63, v71
    v_mfma_f32_16x16x32_bf16 v[100:103], v[52:55], v[20:23], 0
    ds_read_b128 v[104:107], v1 offset:2000
    v_cvt_pk_bf16_f32 v74, v61, v69
    v_cvt_pk_bf16_f32 v75, v62, v70
    v_mfma_f32_16x16x32_bf16 v[60:63], v[64:67], v[24:27], 0
    ds_read2_b32 v[68:69], v38 offset0:19 offset1:16
    v_cvt_pk_bf16_f32 v76, v80, v84
    v_cvt_pk_bf16_f32 v77, v83, v87
    v_mfma_f32_16x16x32_bf16 v[108:111], v[52:55], v[24:27], 0
    ds_read2_b32 v[70:71], v38 offset0:18 offset1:17
    v_cvt_pk_bf16_f32 v78, v81, v85
    v_cvt_pk_bf16_f32 v79, v82, v86
    v_mfma_f32_16x16x32_bf16 v[80:83], v[64:67], v[28:31], 0
    s_waitcnt lgkmcnt(4)
    ds_read_b64 v[84:85], v37 offset:3200
    v_mfma_f32_16x16x32_bf16 v[112:115], v[88:91], v[32:35], 0
    ds_read_b64 v[86:87], v37 offset:3192
    v_mfma_f32_16x16x32_bf16 v[120:123], v[88:91], v[20:23], 0
    ds_read_b64 v[124:125], v37 offset:3312
    v_mfma_f32_16x16x32_bf16 v[128:131], v[56:59], v[20:23], 0
    ds_read_b64 v[126:127], v37 offset:3304
    v_mfma_f32_16x16x32_bf16 v[132:135], v[88:91], v[24:27], 0
    s_waitcnt lgkmcnt(7)
    ds_read2_b32 v[140:141], v3 offset0:132 offset1:126
    v_cvt_pk_bf16_f32 v116, v80, v112
    v_cvt_pk_bf16_f32 v117, v83, v115
    v_mfma_f32_16x16x32_bf16 v[144:147], v[96:99], v[20:23], 0
    s_setprio 3
    ds_read2_b32 v[142:143], v3 offset0:130 offset1:128
    v_cvt_pk_bf16_f32 v118, v81, v113
    v_cvt_pk_bf16_f32 v119, v82, v114
    v_mfma_f32_16x16x32_bf16 v[80:83], v[56:59], v[24:27], 0
    ds_read_b64 v[148:149], v37 offset:3184
    v_cvt_pk_bf16_f32 v88, v92, v60
    v_cvt_pk_bf16_f32 v89, v120, v132
    v_mfma_f32_16x16x32_bf16 v[152:155], v[96:99], v[24:27], 0
    s_waitcnt lgkmcnt(9)
    ds_read_b64 v[150:151], v37 offset:3176
    v_cvt_pk_bf16_f32 v90, v93, v61
    v_cvt_pk_bf16_f32 v91, v121, v133
    v_mfma_f32_16x16x32_bf16 v[156:159], v[104:107], v[20:23], 0
    ds_read2_b32 v[160:161], v38 offset0:35 offset1:32
    v_cvt_pk_bf16_f32 v56, v100, v108
    v_cvt_pk_bf16_f32 v57, v128, v80
    v_mfma_f32_16x16x32_bf16 v[164:167], v[104:107], v[24:27], 0
    ds_read2_b32 v[162:163], v38 offset0:34 offset1:33
    v_cvt_pk_bf16_f32 v58, v101, v109
    v_cvt_pk_bf16_f32 v59, v129, v81
    v_mfma_f32_16x16x32_bf16 v[176:179], v[96:99], v[28:31], 0
    ds_read2_b32 v[28:29], v38 offset0:51 offset1:48
    v_cvt_pk_bf16_f32 v112, v102, v110
    v_cvt_pk_bf16_f32 v113, v130, v82
    v_mfma_f32_16x16x32_bf16 v[180:183], v[104:107], v[32:35], 0
    ds_read_b64 v[104:105], v37 offset:3072
    v_cvt_pk_bf16_f32 v114, v103, v111
    v_cvt_pk_bf16_f32 v115, v131, v83
    v_mfma_f32_16x16x32_bf16 v[80:83], v[56:59], v[44:47], 0
    s_setprio 1
    ds_read_b64 v[106:107], v37 offset:3064
    v_cvt_pk_bf16_f32 v168, v144, v152
    v_cvt_pk_bf16_f32 v169, v156, v164
    v_mfma_f32_16x16x32_bf16 v[80:83], v[72:75], v[48:51], v[80:83]
    s_waitcnt lgkmcnt(11)
    ds_read_b64 v[56:57], v37 offset:3056
    v_cvt_pk_bf16_f32 v170, v145, v153
    v_cvt_pk_bf16_f32 v171, v157, v165
    v_mfma_f32_16x16x32_bf16 v[100:103], v[72:75], v[68:71], 0
    ds_read_b64 v[58:59], v37 offset:3048
    v_cvt_pk_bf16_f32 v172, v146, v154
    v_cvt_pk_bf16_f32 v173, v158, v166
    v_mfma_f32_16x16x32_bf16 v[100:103], v[168:171], v[84:87], v[100:103]
    s_waitcnt lgkmcnt(9)
    ds_read2_b32 v[108:109], v3 offset0:6 offset1:0
    v_cvt_pk_bf16_f32 v174, v147, v155
    v_cvt_pk_bf16_f32 v175, v159, v167
    v_mfma_f32_16x16x32_bf16 v[80:83], v[112:115], v[124:127], v[80:83]
    ds_read2_b32 v[112:113], v2 offset0:230 offset1:224
    v_cvt_pk_bf16_f32 v136, v94, v62
    v_cvt_pk_bf16_f32 v137, v122, v134
    v_mfma_f32_16x16x32_bf16 v[80:83], v[140:143], v[52:55], v[80:83]
    s_waitcnt lgkmcnt(9)
    ds_read2_b32 v[52:53], v36 offset0:230 offset1:224
    v_cvt_pk_bf16_f32 v138, v95, v63
    v_cvt_pk_bf16_f32 v139, v123, v135
    v_mfma_f32_16x16x32_bf16 v[100:103], v[172:175], v[148:151], v[100:103]
    s_waitcnt lgkmcnt(7)
    ds_read2_b32 v[60:61], v36 offset0:198 offset1:192
    v_mov_b32_dpp v30, v28 row_shr:1 row_mask:0xf bank_mask:0xf
    v_mov_b32_dpp v31, v28 row_shr:2 row_mask:0xf bank_mask:0xf
    v_mfma_f32_16x16x32_bf16 v[92:95], v[140:143], v[96:99], 0
    ds_read2_b32 v[120:121], v2 offset0:198 offset1:192
    v_mov_b32_dpp v30, v29 row_shl:2 row_mask:0xf bank_mask:0xf
    v_mov_b32_dpp v31, v29 row_shl:1 row_mask:0xf bank_mask:0xf
    v_mfma_f32_16x16x32_bf16 v[92:95], v[72:75], v[160:163], v[92:95]
    ds_read2_b32 v[122:123], v2 offset0:196 offset1:194
    v_cvt_pk_bf16_f32 v32, v176, v180
    v_cvt_pk_bf16_f32 v33, v179, v183
    s_waitcnt vmcnt(0)
    s_mov_b32 m0, s55
    v_mfma_f32_16x16x32_bf16 v[100:103], v[88:91], v[44:47], v[100:103]
    ds_read2_b32 v[72:73], v2 offset0:166 offset1:160
    v_perm_b32 v128, v16, v12, s38
    v_perm_b32 v129, v16, v12, s39
    v_mfma_f32_16x16x32_bf16 v[92:95], v[76:79], v[28:31], v[92:95]
    s_setprio 1
    ds_write_addtid_b32 v128 offset:0
    ds_write_addtid_b32 v129 offset:4608
    v_perm_b32 v130, v17, v13, s38
    v_perm_b32 v131, v17, v13, s39
    v_mfma_f32_16x16x32_bf16 v[100:103], v[136:139], v[124:127], v[100:103]
    ds_write_addtid_b32 v130 offset:9216
    ds_write_addtid_b32 v131 offset:13824
    v_perm_b32 v132, v18, v14, s38
    v_perm_b32 v133, v18, v14, s39
    v_mfma_f32_16x16x32_bf16 v[92:95], v[116:119], v[68:71], v[92:95]
    ds_write_addtid_b32 v132 offset:18432
    ds_write_addtid_b32 v133 offset:23040
    v_perm_b32 v134, v19, v15, s38
    v_perm_b32 v135, v19, v15, s39
    v_mfma_f32_16x16x32_bf16 v[80:83], v[76:79], v[68:71], v[80:83]
    s_waitcnt lgkmcnt(15)
    ds_write_addtid_b32 v134 offset:27648
    ds_write_addtid_b32 v135 offset:32256
    v_cvt_pk_bf16_f32 v34, v177, v181
    v_cvt_pk_bf16_f32 v35, v178, v182
    v_mfma_f32_16x16x32_bf16 v[80:83], v[168:171], v[104:107], v[80:83]
    s_waitcnt lgkmcnt(14)
    ds_read2_b32 v[10:11], v36 offset0:166 offset1:160
    ds_read2_b32 v[14:15], v2 offset0:134 offset1:128
    v_mov_b32_dpp v110, v108 row_shr:2 row_mask:0xf bank_mask:0xf
    v_mov_b32_dpp v111, v108 row_shr:4 row_mask:0xf bank_mask:0xf
    v_mfma_f32_16x16x32_bf16 v[92:95], v[32:35], v[48:51], v[92:95]
    ds_read2_b32 v[28:29], v36 offset0:134 offset1:128
    v_mov_b32_dpp v110, v109 row_shl:4 row_mask:0xf bank_mask:0xf
    v_mov_b32_dpp v111, v109 row_shl:2 row_mask:0xf bank_mask:0xf
    v_mfma_f32_16x16x32_bf16 v[80:83], v[172:175], v[56:59], v[80:83]
    s_waitcnt lgkmcnt(15)
    ds_read2_b32 v[32:33], v2 offset0:102 offset1:96
    v_mov_b32_dpp v114, v112 row_shr:2 row_mask:0xf bank_mask:0xf
    v_mov_b32_dpp v115, v112 row_shr:4 row_mask:0xf bank_mask:0xf
    s_waitcnt lgkmcnt(4)
    s_barrier
    v_mfma_f32_16x16x32_bf16 v[100:103], v[140:143], v[64:67], v[100:103]
    s_setprio 2
    ds_read_b128 v[64:67], v1 offset:2528
    v_mov_b32_dpp v114, v113 row_shl:4 row_mask:0xf bank_mask:0xf
    v_mov_b32_dpp v115, v113 row_shl:2 row_mask:0xf bank_mask:0xf
    v_mfma_f32_16x16x32_bf16 v[80:83], v[108:111], v[96:99], v[80:83]
    ds_read_b128 v[68:71], v1 offset:2512
    v_mov_b32_dpp v54, v52 row_shr:2 row_mask:0xf bank_mask:0xf
    v_mov_b32_dpp v55, v52 row_shr:4 row_mask:0xf bank_mask:0xf
    v_mfma_f32_16x16x32_bf16 v[80:83], v[88:91], v[84:87], v[80:83]
    ds_read_b128 v[88:91], v1 offset:2592
    v_mov_b32_dpp v54, v53 row_shl:4 row_mask:0xf bank_mask:0xf
    v_mov_b32_dpp v55, v53 row_shl:2 row_mask:0xf bank_mask:0xf
    v_mfma_f32_16x16x32_bf16 v[100:103], v[76:79], v[160:163], v[100:103]
    ds_read_b128 v[76:79], v1 offset:2080
    v_mov_b32_dpp v62, v60 row_shr:2 row_mask:0xf bank_mask:0xf
    v_mov_b32_dpp v63, v60 row_shr:4 row_mask:0xf bank_mask:0xf
    v_mfma_f32_16x16x32_bf16 v[80:83], v[136:139], v[148:151], v[80:83]
    ds_read_b128 v[96:99], v1 offset:2656
    v_mov_b32_dpp v62, v61 row_shl:4 row_mask:0xf bank_mask:0xf
    v_mov_b32_dpp v63, v61 row_shl:2 row_mask:0xf bank_mask:0xf
    v_mfma_f32_16x16x32_bf16 v[92:95], v[168:171], v[44:47], v[92:95]
    s_waitcnt lgkmcnt(4)
    ds_read_b128 v[44:47], v1 offset:2144
    v_mov_b32_dpp v74, v72 row_shr:2 row_mask:0xf bank_mask:0xf
    v_mov_b32_dpp v75, v72 row_shr:4 row_mask:0xf bank_mask:0xf
    v_mfma_f32_16x16x32_bf16 v[128:131], v[64:67], v[20:23], 0
    s_setprio 2
    ds_read_b128 v[132:135], v1 offset:2720
    v_mov_b32_dpp v74, v73 row_shl:4 row_mask:0xf bank_mask:0xf
    v_mov_b32_dpp v75, v73 row_shl:2 row_mask:0xf bank_mask:0xf
    v_mfma_f32_16x16x32_bf16 v[92:95], v[172:175], v[124:127], v[92:95]
    ds_read_b128 v[124:127], v1 offset:2208
    v_mov_b32_dpp v12, v10 row_shr:2 row_mask:0xf bank_mask:0xf
    v_mov_b32_dpp v13, v10 row_shr:4 row_mask:0xf bank_mask:0xf
    v_mfma_f32_16x16x32_bf16 v[136:139], v[64:67], v[24:27], 0
    s_waitcnt lgkmcnt(6)
    ds_read_b128 v[140:143], v1 offset:2784
    v_mov_b32_dpp v12, v11 row_shl:4 row_mask:0xf bank_mask:0xf
    v_mov_b32_dpp v13, v11 row_shl:2 row_mask:0xf bank_mask:0xf
    v_mfma_f32_16x16x32_bf16 v[144:147], v[68:71], v[20:23], 0
    ds_read_b128 v[152:155], v1 offset:2272
    v_mov_b32_dpp v16, v14 row_shr:2 row_mask:0xf bank_mask:0xf
    v_mov_b32_dpp v17, v14 row_shr:4 row_mask:0xf bank_mask:0xf
    v_mfma_f32_16x16x32_bf16 v[156:159], v[68:71], v[24:27], 0
    ds_read2_b32 v[164:165], v36 offset0:102 offset1:96
    v_mov_b32_dpp v16, v15 row_shl:4 row_mask:0xf bank_mask:0xf
    v_mov_b32_dpp v17, v15 row_shl:2 row_mask:0xf bank_mask:0xf
    v_mfma_f32_16x16x32_bf16 v[100:103], v[116:119], v[48:51], v[100:103]
    s_waitcnt lgkmcnt(7)
    ds_read_b128 v[48:51], v1 offset:2848
    v_mov_b32_dpp v30, v28 row_shr:2 row_mask:0xf bank_mask:0xf
    v_mov_b32_dpp v31, v28 row_shr:4 row_mask:0xf bank_mask:0xf
    v_mfma_f32_16x16x32_bf16 v[80:83], v[112:115], v[88:91], v[80:83]
    ds_read_b128 v[116:119], v1 offset:2336
    v_mov_b32_dpp v30, v29 row_shl:4 row_mask:0xf bank_mask:0xf
    v_mov_b32_dpp v31, v29 row_shl:2 row_mask:0xf bank_mask:0xf
    v_mfma_f32_16x16x32_bf16 v[80:83], v[52:55], v[76:79], v[80:83]
    s_waitcnt lgkmcnt(7)
    ds_read2_b32 v[76:77], v36 offset0:70 offset1:64
    v_mov_b32_dpp v34, v32 row_shr:2 row_mask:0xf bank_mask:0xf
    v_mov_b32_dpp v35, v32 row_shr:4 row_mask:0xf bank_mask:0xf
    v_mfma_f32_16x16x32_bf16 v[80:83], v[120:123], v[96:99], v[80:83]
    ds_read2_b32 v[168:169], v2 offset0:70 offset1:64
    v_mov_b32_dpp v34, v33 row_shl:4 row_mask:0xf bank_mask:0xf
    v_mov_b32_dpp v35, v33 row_shl:2 row_mask:0xf bank_mask:0xf
    v_mfma_f32_16x16x32_bf16 v[80:83], v[60:63], v[44:47], v[80:83]
    s_waitcnt lgkmcnt(4)
    ds_read2_b32 v[170:171], v2 offset0:68 offset1:66
    v_mov_b32_dpp v166, v164 row_shr:2 row_mask:0xf bank_mask:0xf
    v_mov_b32_dpp v167, v164 row_shr:4 row_mask:0xf bank_mask:0xf
    v_mfma_f32_16x16x32_bf16 v[80:83], v[72:75], v[132:135], v[80:83]
    ds_read_b128 v[44:47], v1 offset:2912
    v_mov_b32_dpp v166, v165 row_shl:4 row_mask:0xf bank_mask:0xf
    v_mov_b32_dpp v167, v165 row_shl:2 row_mask:0xf bank_mask:0xf
    v_mfma_f32_16x16x32_bf16 v[80:83], v[10:13], v[124:127], v[80:83]
    s_waitcnt lgkmcnt(3)
    ds_read2_b32 v[124:125], v2 offset0:38 offset1:32
    v_mov_b32_dpp v78, v76 row_shr:2 row_mask:0xf bank_mask:0xf
    v_mov_b32_dpp v79, v76 row_shr:4 row_mask:0xf bank_mask:0xf
    v_mfma_f32_16x16x32_bf16 v[80:83], v[14:17], v[140:143], v[80:83]
    ds_read_b128 v[172:175], v1 offset:2400
    v_mov_b32_dpp v78, v77 row_shl:4 row_mask:0xf bank_mask:0xf
    v_mov_b32_dpp v79, v77 row_shl:2 row_mask:0xf bank_mask:0xf
    v_mfma_f32_16x16x32_bf16 v[80:83], v[28:31], v[152:155], v[80:83]
    s_waitcnt lgkmcnt(1)
    ds_read2_b32 v[152:153], v36 offset0:38 offset1:32
    v_mov_b32_dpp v126, v124 row_shr:2 row_mask:0xf bank_mask:0xf
    v_mov_b32_dpp v127, v124 row_shr:4 row_mask:0xf bank_mask:0xf
    v_mfma_f32_16x16x32_bf16 v[80:83], v[32:35], v[48:51], v[80:83]
    ds_read_b128 v[176:179], v1 offset:2976
    v_mov_b32_dpp v126, v125 row_shl:4 row_mask:0xf bank_mask:0xf
    v_mov_b32_dpp v127, v125 row_shl:2 row_mask:0xf bank_mask:0xf
    v_mfma_f32_16x16x32_bf16 v[80:83], v[164:167], v[116:119], v[80:83]
    s_waitcnt lgkmcnt(1)
    ds_read2_b32 v[116:117], v2 offset0:6 offset1:0
    v_mov_b32_dpp v154, v152 row_shr:2 row_mask:0xf bank_mask:0xf
    v_mov_b32_dpp v155, v152 row_shr:4 row_mask:0xf bank_mask:0xf
    v_mfma_f32_16x16x32_bf16 v[80:83], v[168:171], v[44:47], v[80:83]
    ds_read_b128 v[180:183], v1 offset:2464
    v_mov_b32_dpp v154, v153 row_shl:4 row_mask:0xf bank_mask:0xf
    v_mov_b32_dpp v155, v153 row_shl:2 row_mask:0xf bank_mask:0xf
    v_mfma_f32_16x16x32_bf16 v[80:83], v[76:79], v[172:175], v[80:83]
    s_waitcnt lgkmcnt(1)
    ds_read_b128 v[172:175], v1 offset:3040
    v_mov_b32_dpp v118, v116 row_shr:2 row_mask:0xf bank_mask:0xf
    v_mov_b32_dpp v119, v116 row_shr:4 row_mask:0xf bank_mask:0xf
    v_mfma_f32_16x16x32_bf16 v[80:83], v[124:127], v[176:179], v[80:83]
    ds_read2_b32 v[184:185], v36 offset0:6 offset1:0
    v_mov_b32_dpp v118, v117 row_shl:4 row_mask:0xf bank_mask:0xf
    v_mov_b32_dpp v119, v117 row_shl:2 row_mask:0xf bank_mask:0xf
    s_waitcnt lgkmcnt(2)
    v_mfma_f32_16x16x32_bf16 v[80:83], v[152:155], v[180:183], v[80:83]
    ds_read2_b32 v[186:187], v36 offset0:4 offset1:2
    v_cvt_pk_bf16_f32 v68, v128, v136
    v_cvt_pk_bf16_f32 v69, v144, v156
    s_waitcnt lgkmcnt(2)
    v_mfma_f32_16x16x32_bf16 v[80:83], v[116:119], v[172:175], v[80:83]
    ds_read_b128 v[180:183], v1 offset:3104
    v_cvt_pk_bf16_f32 v70, v129, v137
    v_cvt_pk_bf16_f32 v71, v145, v157
    s_waitcnt lgkmcnt(1)
    v_mfma_f32_16x16x32_bf16 v[80:83], v[184:187], v[64:67], v[80:83]
    ds_read_b128 v[188:191], v1 offset:3168
    v_cvt_pk_bf16_f32 v160, v130, v138
    v_cvt_pk_bf16_f32 v161, v146, v158
    v_mfma_f32_16x16x32_bf16 v[100:103], v[68:71], v[104:107], v[100:103]
    s_setprio 3
    ds_read_b128 v[192:195], v1 offset:3232
    v_cvt_pk_bf16_f32 v162, v131, v139
    v_cvt_pk_bf16_f32 v163, v147, v159
    s_nop 1
    v_mfma_f32_16x16x32_bf16 v[100:103], v[160:163], v[56:59], v[100:103]
    ds_read_b128 v[128:131], v1 offset:3296
    s_nop 1
    v_mfma_f32_16x16x32_bf16 v[100:103], v[52:55], v[88:91], v[100:103]
    s_setprio 2
    ds_read_b128 v[88:91], v1 offset:3360
    v_cvt_pk_bf16_f32 v4, v80, v81
    v_cvt_pk_bf16_f32 v5, v82, v83
    v_mfma_f32_16x16x32_bf16 v[100:103], v[60:63], v[96:99], v[100:103]
    ds_write_b64 v39, v[4:5] offset:6976
    v_mfma_f32_16x16x32_bf16 v[100:103], v[10:13], v[132:135], v[100:103]
    s_setprio 0
    ds_read_b128 v[80:83], v1 offset:3424
    v_mfma_f32_16x16x32_bf16 v[100:103], v[28:31], v[140:143], v[100:103]
    ds_read_b128 v[96:99], v1 offset:3488
    v_mfma_f32_16x16x32_bf16 v[100:103], v[164:167], v[48:51], v[100:103]
    ds_read_b128 v[48:51], v1 offset:3552
    s_waitcnt lgkmcnt(3)
    s_barrier
    v_mfma_f32_16x16x32_bf16 v[100:103], v[76:79], v[44:47], v[100:103]
    s_nop 0
    ds_read_b64_tr_b16 v[6:7], v40 offset:0
    ds_read_b128 v[44:47], v1 offset:3024
    v_mfma_f32_16x16x32_bf16 v[100:103], v[152:155], v[176:179], v[100:103]
    ds_read_b64_tr_b16 v[8:9], v40 offset:46336
    s_add_u32 s48, s34, 2621440
    v_mfma_f32_16x16x32_bf16 v[100:103], v[108:111], v[64:67], v[100:103]
    ds_read_b128 v[64:67], v1 offset:3616
    v_mfma_f32_16x16x32_bf16 v[100:103], v[184:187], v[172:175], v[100:103]
    ds_read_b128 v[132:135], v1 offset:3680
    s_mov_b64 exec, s[26:27]
    s_waitcnt lgkmcnt(2)
    buffer_store_dwordx4 v[6:9], v41, s[60:63], s48 offen
    s_mov_b64 exec, -1
    v_mfma_f32_16x16x32_bf16 v[100:103], v[112:115], v[180:183], v[100:103]
    ds_read_b128 v[136:139], v1 offset:3744
    v_mfma_f32_16x16x32_bf16 v[100:103], v[120:123], v[188:191], v[100:103]
    ds_read_b128 v[140:143], v1 offset:3808
    v_mfma_f32_16x16x32_bf16 v[100:103], v[72:75], v[192:195], v[100:103]
    ds_read_b128 v[144:147], v1 offset:3872
    v_mfma_f32_16x16x32_bf16 v[100:103], v[14:17], v[128:131], v[100:103]
    ds_read_b128 v[156:159], v1 offset:3936
    v_mfma_f32_16x16x32_bf16 v[100:103], v[32:35], v[88:91], v[100:103]
    ds_read_b128 v[176:179], v1 offset:4000
    v_mfma_f32_16x16x32_bf16 v[100:103], v[168:171], v[80:83], v[100:103]
    ds_read_b128 v[196:199], v1 offset:4064
    v_mfma_f32_16x16x32_bf16 v[100:103], v[124:127], v[96:99], v[100:103]
    v_mfma_f32_16x16x32_bf16 v[100:103], v[116:119], v[48:51], v[100:103]
    v_mfma_f32_16x16x32_bf16 v[92:95], v[108:111], v[172:175], v[92:95]
    s_nop 2
    v_mfma_f32_16x16x32_bf16 v[108:111], v[172:175], v[20:23], 0
    s_nop 2
    v_mfma_f32_16x16x32_bf16 v[92:95], v[68:71], v[84:87], v[92:95]
    s_setprio 0
    v_cvt_pk_bf16_f32 v4, v100, v101
    v_cvt_pk_bf16_f32 v5, v102, v103
    v_mfma_f32_16x16x32_bf16 v[68:71], v[172:175], v[24:27], 0
    ds_write_b64 v39, v[4:5] offset:7616
    v_mfma_f32_16x16x32_bf16 v[92:95], v[52:55], v[180:183], v[92:95]
    v_mfma_f32_16x16x32_bf16 v[92:95], v[160:163], v[148:151], v[92:95]
    v_mfma_f32_16x16x32_bf16 v[52:55], v[44:47], v[20:23], 0
    s_waitcnt lgkmcnt(0)
    s_barrier
    v_mfma_f32_16x16x32_bf16 v[92:95], v[60:63], v[188:191], v[92:95]
    ds_read_b64_tr_b16 v[6:7], v40 offset:640
    v_mfma_f32_16x16x32_bf16 v[18:21], v[44:47], v[24:27], 0
    ds_read_b64_tr_b16 v[8:9], v40 offset:46976
    s_add_u32 s48, s34, 3145728
    v_mfma_f32_16x16x32_bf16 v[92:95], v[10:13], v[192:195], v[92:95]
    v_mfma_f32_16x16x32_bf16 v[92:95], v[112:115], v[64:67], v[92:95]
    s_mov_b64 exec, s[26:27]
    s_waitcnt lgkmcnt(0)
    buffer_store_dwordx4 v[6:9], v41, s[60:63], s48 offen
    s_mov_b64 exec, -1
    v_mfma_f32_16x16x32_bf16 v[92:95], v[28:31], v[128:131], v[92:95]
    s_setprio 3
    v_cvt_pk_bf16_f32 v22, v108, v68
    v_cvt_pk_bf16_f32 v23, v52, v18
    v_mfma_f32_16x16x32_bf16 v[92:95], v[120:123], v[132:135], v[92:95]
    v_cvt_pk_bf16_f32 v24, v109, v69
    v_cvt_pk_bf16_f32 v25, v53, v19
    v_mfma_f32_16x16x32_bf16 v[92:95], v[164:167], v[88:91], v[92:95]
    s_setprio 3
    v_cvt_pk_bf16_f32 v44, v110, v70
    v_cvt_pk_bf16_f32 v45, v54, v20
    v_mfma_f32_16x16x32_bf16 v[92:95], v[76:79], v[80:83], v[92:95]
    v_cvt_pk_bf16_f32 v46, v111, v71
    v_cvt_pk_bf16_f32 v47, v55, v21
    v_mfma_f32_16x16x32_bf16 v[92:95], v[72:75], v[136:139], v[92:95]
    v_mfma_f32_16x16x32_bf16 v[92:95], v[152:155], v[96:99], v[92:95]
    v_mfma_f32_16x16x32_bf16 v[92:95], v[14:17], v[140:143], v[92:95]
    v_mfma_f32_16x16x32_bf16 v[92:95], v[184:187], v[48:51], v[92:95]
    s_setprio 1
    v_mfma_f32_16x16x32_bf16 v[92:95], v[22:25], v[104:107], v[92:95]
    v_mfma_f32_16x16x32_bf16 v[92:95], v[32:35], v[144:147], v[92:95]
    v_mfma_f32_16x16x32_bf16 v[92:95], v[44:47], v[56:59], v[92:95]
    v_mfma_f32_16x16x32_bf16 v[92:95], v[168:171], v[156:159], v[92:95]
    s_setprio 1
    v_mfma_f32_16x16x32_bf16 v[92:95], v[124:127], v[176:179], v[92:95]
    v_mfma_f32_16x16x32_bf16 v[92:95], v[116:119], v[196:199], v[92:95]
    s_nop 7
    v_cvt_pk_bf16_f32 v4, v92, v93
    v_cvt_pk_bf16_f32 v5, v94, v95
    ds_write_b64 v39, v[4:5] offset:8256
    s_waitcnt lgkmcnt(0)
    s_barrier
    ds_read_b64_tr_b16 v[6:7], v40 offset:1280
    ds_read_b64_tr_b16 v[8:9], v40 offset:47616
    s_add_u32 s48, s34, 3670016
    s_mov_b64 exec, s[26:27]
    s_waitcnt lgkmcnt(0)
    buffer_store_dwordx4 v[6:9], v41, s[60:63], s48 offen
    s_mov_b64 exec, -1
    s_endpgm
L_end:
    s_endpgm
L_slow:
    s_lshl_b32 s13, s33, 7
    v_lshl_add_u32 v76, v0, 2, s13
    global_load_dword v77, v76, s[8:9]
    v_and_b32 v78, 15, v0
    v_lshlrev_b32 v78, 3, v78
    v_cvt_f32_u32 v78, v78
    s_bfm_b64 exec, 16, 0
    v_add_f32 v64, 0x0, v78
    v_add_f32 v65, 0x3f800000, v78
    v_add_f32 v66, 0x40000000, v78
    v_add_f32 v67, 0x40400000, v78
    v_add_f32 v80, 0x40800000, v78
    v_add_f32 v81, 0x44010000, v78
    v_add_f32 v82, 0x44020000, v78
    v_add_f32 v83, 0x44810000, v78
    s_bfm_b64 exec, 16, 16
    v_add_f32 v64, 0x40800000, v78
    v_add_f32 v65, 0x40a00000, v78
    v_add_f32 v66, 0x40c00000, v78
    v_add_f32 v67, 0x40e00000, v78
    v_add_f32 v80, 0x41000000, v78
    v_add_f32 v81, 0x44410000, v78
    v_add_f32 v82, 0x44420000, v78
    v_add_f32 v83, 0x44a10000, v78
    s_bfm_b64 exec, 16, 32
    v_add_f32 v64, 0x43800000, v78
    v_add_f32 v65, 0x43800000, v78
    v_add_f32 v66, 0x43810000, v78
    v_add_f32 v67, 0x43820000, v78
    v_add_f32 v80, 0x43820000, v78
    v_add_f32 v81, 0x0, v78
    v_add_f32 v82, 0x0, v78
    v_add_f32 v83, 0x44c10000, v78
    s_bfm_b64 exec, 16, 48
    v_add_f32 v64, 0x43820000, v78
    v_add_f32 v65, 0x43820000, v78
    v_add_f32 v66, 0x43830000, v78
    v_add_f32 v67, 0x43840000, v78
    v_add_f32 v80, 0x43840000, v78
    v_add_f32 v81, 0x43840000, v78
    v_add_f32 v82, 0x43840000, v78
    v_add_f32 v83, 0x44e10000, v78
    s_mov_b64 exec, -1
    v_add_f32 v68, 0x43000000, v64
    v_mov_b32 v44, 0
    v_mov_b32 v48, 0
    v_add_f32 v69, 0x43000000, v65
    v_mov_b32 v45, 0
    v_mov_b32 v49, 0
    v_add_f32 v70, 0x43000000, v66
    v_mov_b32 v46, 0
    v_mov_b32 v50, 0
    v_add_f32 v71, 0x43000000, v67
    v_mov_b32 v47, 0
    v_mov_b32 v51, 0
    v_add_f32 v84, 0x43000000, v80
    v_mov_b32 v52, 0
    v_mov_b32 v56, 0
    v_add_f32 v85, 0x43000000, v81
    v_mov_b32 v53, 0
    v_mov_b32 v57, 0
    v_add_f32 v86, 0x43000000, v82
    v_mov_b32 v54, 0
    v_mov_b32 v58, 0
    v_add_f32 v87, 0x43000000, v83
    v_mov_b32 v55, 0
    v_mov_b32 v59, 0
    s_waitcnt vmcnt(0)
    v_lshlrev_b32 v72, 16, v77
    v_and_b32 v73, s51, v77
    v_mul_f32 v72, v72, v193
    v_mul_f32 v73, v73, v193
    v_mov_b32 v160, v193
    s_mov_b32 s28, 0x31dc9c88
    s_mov_b32 s29, 0
L_slow_mode:
    s_and_b32 s30, s29, 63
    v_readlane_b32 s10, v174, s30
    v_readlane_b32 s11, v72, s30
    v_readlane_b32 s12, v180, s30
    v_readlane_b32 s13, v182, s30
    v_mul_f32 v76, s11, v64
    v_mul_f32 v77, 0.15915494, v76
    v_fma_f32 v78, v76, 0.15915494, -v77
    v_fma_f32 v78, v76, s28, v78
    v_rndne_f32 v76, v77
    v_sub_f32 v77, v77, v76
    v_add_f32 v77, v77, v78
    v_mul_f32 v76, s10, v64
    v_cos_f32 v78, v77
    v_sin_f32 v79, v77
    v_exp_f32 v76, v76
    v_mul_f32 v78, s12, v78
    v_fma_f32 v78, -v79, s13, v78
    v_fma_f32 v44, v76, v78, v44
    v_mul_f32 v76, s11, v65
    v_mul_f32 v77, 0.15915494, v76
    v_fma_f32 v78, v76, 0.15915494, -v77
    v_fma_f32 v78, v76, s28, v78
    v_rndne_f32 v76, v77
    v_sub_f32 v77, v77, v76
    v_add_f32 v77, v77, v78
    v_mul_f32 v76, s10, v65
    v_cos_f32 v78, v77
    v_sin_f32 v79, v77
    v_exp_f32 v76, v76
    v_mul_f32 v78, s12, v78
    v_fma_f32 v78, -v79, s13, v78
    v_fma_f32 v45, v76, v78, v45
    v_mul_f32 v76, s11, v66
    v_mul_f32 v77, 0.15915494, v76
    v_fma_f32 v78, v76, 0.15915494, -v77
    v_fma_f32 v78, v76, s28, v78
    v_rndne_f32 v76, v77
    v_sub_f32 v77, v77, v76
    v_add_f32 v77, v77, v78
    v_mul_f32 v76, s10, v66
    v_cos_f32 v78, v77
    v_sin_f32 v79, v77
    v_exp_f32 v76, v76
    v_mul_f32 v78, s12, v78
    v_fma_f32 v78, -v79, s13, v78
    v_fma_f32 v46, v76, v78, v46
    v_mul_f32 v76, s11, v67
    v_mul_f32 v77, 0.15915494, v76
    v_fma_f32 v78, v76, 0.15915494, -v77
    v_fma_f32 v78, v76, s28, v78
    v_rndne_f32 v76, v77
    v_sub_f32 v77, v77, v76
    v_add_f32 v77, v77, v78
    v_mul_f32 v76, s10, v67
    v_cos_f32 v78, v77
    v_sin_f32 v79, v77
    v_exp_f32 v76, v76
    v_mul_f32 v78, s12, v78
    v_fma_f32 v78, -v79, s13, v78
    v_fma_f32 v47, v76, v78, v47
    v_mul_f32 v76, s11, v68
    v_mul_f32 v77, 0.15915494, v76
    v_fma_f32 v78, v76, 0.15915494, -v77
    v_fma_f32 v78, v76, s28, v78
    v_rndne_f32 v76, v77
    v_sub_f32 v77, v77, v76
    v_add_f32 v77, v77, v78
    v_mul_f32 v76, s10, v68
    v_cos_f32 v78, v77
    v_sin_f32 v79, v77
    v_exp_f32 v76, v76
    v_mul_f32 v78, s12, v78
    v_fma_f32 v78, -v79, s13, v78
    v_fma_f32 v48, v76, v78, v48
    v_mul_f32 v76, s11, v69
    v_mul_f32 v77, 0.15915494, v76
    v_fma_f32 v78, v76, 0.15915494, -v77
    v_fma_f32 v78, v76, s28, v78
    v_rndne_f32 v76, v77
    v_sub_f32 v77, v77, v76
    v_add_f32 v77, v77, v78
    v_mul_f32 v76, s10, v69
    v_cos_f32 v78, v77
    v_sin_f32 v79, v77
    v_exp_f32 v76, v76
    v_mul_f32 v78, s12, v78
    v_fma_f32 v78, -v79, s13, v78
    v_fma_f32 v49, v76, v78, v49
    v_mul_f32 v76, s11, v70
    v_mul_f32 v77, 0.15915494, v76
    v_fma_f32 v78, v76, 0.15915494, -v77
    v_fma_f32 v78, v76, s28, v78
    v_rndne_f32 v76, v77
    v_sub_f32 v77, v77, v76
    v_add_f32 v77, v77, v78
    v_mul_f32 v76, s10, v70
    v_cos_f32 v78, v77
    v_sin_f32 v79, v77
    v_exp_f32 v76, v76
    v_mul_f32 v78, s12, v78
    v_fma_f32 v78, -v79, s13, v78
    v_fma_f32 v50, v76, v78, v50
    v_mul_f32 v76, s11, v71
    v_mul_f32 v77, 0.15915494, v76
    v_fma_f32 v78, v76, 0.15915494, -v77
    v_fma_f32 v78, v76, s28, v78
    v_rndne_f32 v76, v77
    v_sub_f32 v77, v77, v76
    v_add_f32 v77, v77, v78
    v_mul_f32 v76, s10, v71
    v_cos_f32 v78, v77
    v_sin_f32 v79, v77
    v_exp_f32 v76, v76
    v_mul_f32 v78, s12, v78
    v_fma_f32 v78, -v79, s13, v78
    v_fma_f32 v51, v76, v78, v51
    v_mul_f32 v76, s11, v80
    v_mul_f32 v77, 0.15915494, v76
    v_fma_f32 v78, v76, 0.15915494, -v77
    v_fma_f32 v78, v76, s28, v78
    v_rndne_f32 v76, v77
    v_sub_f32 v77, v77, v76
    v_add_f32 v77, v77, v78
    v_mul_f32 v76, s10, v80
    v_cos_f32 v78, v77
    v_sin_f32 v79, v77
    v_exp_f32 v76, v76
    v_mul_f32 v78, s12, v78
    v_fma_f32 v78, -v79, s13, v78
    v_fma_f32 v52, v76, v78, v52
    v_mul_f32 v76, s11, v81
    v_mul_f32 v77, 0.15915494, v76
    v_fma_f32 v78, v76, 0.15915494, -v77
    v_fma_f32 v78, v76, s28, v78
    v_rndne_f32 v76, v77
    v_sub_f32 v77, v77, v76
    v_add_f32 v77, v77, v78
    v_mul_f32 v76, s10, v81
    v_cos_f32 v78, v77
    v_sin_f32 v79, v77
    v_exp_f32 v76, v76
    v_mul_f32 v78, s12, v78
    v_fma_f32 v78, -v79, s13, v78
    v_fma_f32 v53, v76, v78, v53
    v_mul_f32 v76, s11, v82
    v_mul_f32 v77, 0.15915494, v76
    v_fma_f32 v78, v76, 0.15915494, -v77
    v_fma_f32 v78, v76, s28, v78
    v_rndne_f32 v76, v77
    v_sub_f32 v77, v77, v76
    v_add_f32 v77, v77, v78
    v_mul_f32 v76, s10, v82
    v_cos_f32 v78, v77
    v_sin_f32 v79, v77
    v_exp_f32 v76, v76
    v_mul_f32 v78, s12, v78
    v_fma_f32 v78, -v79, s13, v78
    v_fma_f32 v54, v76, v78, v54
    v_mul_f32 v76, s11, v83
    v_mul_f32 v77, 0.15915494, v76
    v_fma_f32 v78, v76, 0.15915494, -v77
    v_fma_f32 v78, v76, s28, v78
    v_rndne_f32 v76, v77
    v_sub_f32 v77, v77, v76
    v_add_f32 v77, v77, v78
    v_mul_f32 v76, s10, v83
    v_cos_f32 v78, v77
    v_sin_f32 v79, v77
    v_exp_f32 v76, v76
    v_mul_f32 v78, s12, v78
    v_fma_f32 v78, -v79, s13, v78
    v_fma_f32 v55, v76, v78, v55
    v_mul_f32 v76, s11, v84
    v_mul_f32 v77, 0.15915494, v76
    v_fma_f32 v78, v76, 0.15915494, -v77
    v_fma_f32 v78, v76, s28, v78
    v_rndne_f32 v76, v77
    v_sub_f32 v77, v77, v76
    v_add_f32 v77, v77, v78
    v_mul_f32 v76, s10, v84
    v_cos_f32 v78, v77
    v_sin_f32 v79, v77
    v_exp_f32 v76, v76
    v_mul_f32 v78, s12, v78
    v_fma_f32 v78, -v79, s13, v78
    v_fma_f32 v56, v76, v78, v56
    v_mul_f32 v76, s11, v85
    v_mul_f32 v77, 0.15915494, v76
    v_fma_f32 v78, v76, 0.15915494, -v77
    v_fma_f32 v78, v76, s28, v78
    v_rndne_f32 v76, v77
    v_sub_f32 v77, v77, v76
    v_add_f32 v77, v77, v78
    v_mul_f32 v76, s10, v85
    v_cos_f32 v78, v77
    v_sin_f32 v79, v77
    v_exp_f32 v76, v76
    v_mul_f32 v78, s12, v78
    v_fma_f32 v78, -v79, s13, v78
    v_fma_f32 v57, v76, v78, v57
    v_mul_f32 v76, s11, v86
    v_mul_f32 v77, 0.15915494, v76
    v_fma_f32 v78, v76, 0.15915494, -v77
    v_fma_f32 v78, v76, s28, v78
    v_rndne_f32 v76, v77
    v_sub_f32 v77, v77, v76
    v_add_f32 v77, v77, v78
    v_mul_f32 v76, s10, v86
    v_cos_f32 v78, v77
    v_sin_f32 v79, v77
    v_exp_f32 v76, v76
    v_mul_f32 v78, s12, v78
    v_fma_f32 v78, -v79, s13, v78
    v_fma_f32 v58, v76, v78, v58
    v_mul_f32 v76, s11, v87
    v_mul_f32 v77, 0.15915494, v76
    v_fma_f32 v78, v76, 0.15915494, -v77
    v_fma_f32 v78, v76, s28, v78
    v_rndne_f32 v76, v77
    v_sub_f32 v77, v77, v76
    v_add_f32 v77, v77, v78
    v_mul_f32 v76, s10, v87
    v_cos_f32 v78, v77
    v_sin_f32 v79, v77
    v_exp_f32 v76, v76
    v_mul_f32 v78, s12, v78
    v_fma_f32 v78, -v79, s13, v78
    v_fma_f32 v59, v76, v78, v59
    s_add_u32 s29, s29, 1
    s_cmp_lg_u32 s29, 64
    s_cbranch_scc1 L_slow_next
    v_mov_b32 v174, v175
    v_mov_b32 v72, v73
    v_mov_b32 v180, v181
    v_mov_b32 v182, v183
L_slow_next:
    s_cmpk_lt_u32 s29, 128
    s_cbranch_scc1 L_slow_mode
    s_bfm_b64 exec, 16, 32
    v_mov_b32 v53, 0
    v_mov_b32 v54, 0
    v_mov_b32 v57, 0
    v_mov_b32 v58, 0
    s_mov_b64 exec, -1
    v_fma_f32 v44, v44, v160, v161
    v_mul_f32 v45, v160, v45
    v_mul_f32 v46, v160, v46
    v_mul_f32 v47, v160, v47
    v_cvt_pk_bf16_f32 v128, v45, v44
    v_cvt_pk_bf16_f32 v129, v46, v45
    v_mul_f32 v52, v160, v52
    v_cvt_pk_bf16_f32 v130, v47, v46
    v_cvt_pk_bf16_f32 v131, v52, v47
    ds_write_b128 v43, v[128:131] offset:256
    v_mul_f32 v53, v160, v53
    v_mul_f32 v54, v160, v54
    v_mul_f32 v55, v160, v55
    v_cvt_pk_bf16_f32 v136, v53, v54
    s_mov_b64 exec, 1
    v_lshrrev_b32 v63, 16, v128
    s_mov_b64 exec, -1
    v_mul_f32 v48, v160, v48
    v_mul_f32 v49, v160, v49
    v_mul_f32 v50, v160, v50
    v_mul_f32 v51, v160, v51
    v_cvt_pk_bf16_f32 v132, v49, v48
    v_cvt_pk_bf16_f32 v133, v50, v49
    v_mul_f32 v56, v160, v56
    v_cvt_pk_bf16_f32 v134, v51, v50
    v_cvt_pk_bf16_f32 v135, v56, v51
    ds_write_b128 v43, v[132:135] offset:768
    v_mul_f32 v57, v160, v57
    v_mul_f32 v58, v160, v58
    v_mul_f32 v59, v160, v59
    v_cvt_pk_bf16_f32 v137, v57, v58
    ds_write2_b32 v165, v136, v137 offset0:0 offset1:16
    v_cvt_pk_bf16_f32 v138, v55, v59
    ds_write_b16 v166, v138 offset:3456
    ds_write_b16_d16_hi v166, v138 offset:3488
    s_brev_b32 exec_lo, 1
    s_brev_b32 exec_hi, 1
    v_and_b32 v62, s51, v137
    v_lshrrev_b32 v60, v167, v137
    v_or_b32 v61, v60, v62
    s_mov_b64 exec, -1
    ds_write_b128 v163, v[60:63] offset:240
    s_waitcnt lgkmcnt(0)
    s_bitcmp1_b32 s2, 3
    s_cbranch_scc1 L_back_hi
    s_branch L_back_lo
.fill 908, 4, 0xbf810000
.section .rodata,"a"
.p2align 6
.amdhsa_kernel concat_heads__ssm_conv_s4d__ssm_conv_s4__prompt_kernel
  .amdhsa_next_free_vgpr 256
  .amdhsa_next_free_sgpr 102
  .amdhsa_accum_offset 256
  .amdhsa_group_segment_fixed_size 0
  .amdhsa_kernarg_size 152
  .amdhsa_user_sgpr_count 2
  .amdhsa_user_sgpr_kernarg_segment_ptr 1
  .amdhsa_system_sgpr_workgroup_id_x 1
.end_amdhsa_kernel
```
